```python
import torch

def _softmax(x, axis=-1):
    return torch.softmax(x, dim=axis)
def _gelu(x):
    return torch.nn.functional.gelu(x, approximate="tanh")
def _silu(x):
    return torch.nn.functional.silu(x)
def _sigmoid(x):
    return torch.sigmoid(x)
def _layernorm(x, axis=-1, eps=1e-5):
    m = x.mean(dim=axis, keepdim=True)
    v = x.var(dim=axis, keepdim=True, unbiased=False)
    return (x - m) / torch.sqrt(v + eps)
def _scatter_add(tgt, idx, src, axis=0):
    return tgt.clone().index_add_(axis, idx, src)
def _segment_sum(src, seg, n):
    out = torch.zeros((n,) + src.shape[1:], dtype=src.dtype)
    return out.index_add_(0, seg, src)
def _pad(x, pw):
    flat = tuple(v for pair in reversed(pw) for v in pair)
    return torch.nn.functional.pad(x, flat)

kernel_name = 'sequential_preLN__sliding_block__dense_activation_squared_relu__prompt'

def setup_inputs():

    _w = (lambda a: (lambda t: t.to(torch.bfloat16) if t.is_floating_point() else t)(torch.as_tensor(a)))
    def _A_setup():
        B, S, D = 1, 2048, 512
        return {
            "x": _w((lambda *s: torch.randn(*s, dtype=torch.bfloat16) * 0.05)(B, S, D)),
            "wqkv": _w((lambda *s: torch.randn(*s, dtype=torch.bfloat16) * 0.05)(D, 3 * D)),
            "wo": _w((lambda *s: torch.randn(*s, dtype=torch.bfloat16) * 0.05)(D, D)),
        }
    _A_in = _A_setup()

    def _B_setup():
        B, S, D, F = 1, 2048, 512, 1376
        return {
            "x": _w((lambda *s: torch.randn(*s, dtype=torch.bfloat16) * 0.05)(B, S, D)),
            "w1": _w((lambda *s: torch.randn(*s, dtype=torch.bfloat16) * 0.05)(D, F)),
            "b1": _w((lambda *s: torch.randn(*s, dtype=torch.bfloat16) * 0.4)(F)),
            "w2": _w((lambda *s: torch.randn(*s, dtype=torch.bfloat16) * 0.05)(F, D)),
            "b2": _w((lambda *s: torch.randn(*s, dtype=torch.bfloat16) * 1.6)(D)),
        }
    _B_in = _B_setup()

    return {
        "A_x": _A_in["x"],
        "A_wqkv": _A_in["wqkv"],
        "A_wo": _A_in["wo"],
        "B_x": _B_in["x"],
        "B_w1": _B_in["w1"],
        "B_b1": _B_in["b1"],
        "B_w2": _B_in["w2"],
        "B_b2": _B_in["b2"],
    }

def reference(A_x, A_wqkv, A_wo, B_x, B_w1, B_b1, B_w2, B_b2):
    def _A_ref(x, wqkv, wo):
        B, S, D = x.shape
        H = 32; Dh = D // H; W = 256
        qkv = (lambda x, *d: x.permute(*d))((x @ wqkv).reshape(B, S, 3, H, Dh), 2, 0, 3, 1, 4)
        q, k, v = qkv[0], qkv[1], qkv[2]
        scores = torch.einsum("bhqd,bhkd->bhqk", q, k) * (Dh ** -0.5)
        idx = torch.arange(S)
        mask = (idx[:, None] - idx[None, :] >= 0) & (idx[:, None] - idx[None, :] < W)
        scores = torch.where(mask[None, None], scores, -1e9)
        p = _softmax(scores, axis=-1)
        o = torch.einsum("bhqk,bhkd->bhqd", p, v)
        return (lambda x, *d: x.permute(*d))(o, 0, 2, 1, 3).reshape(B, S, D) @ wo

    def _B_ref(x, w1, b1, w2, b2):
        h = torch.einsum("bsd,df->bsf", x, w1) + b1
        zero = torch.zeros_like(h)
        r = torch.where(h > zero, h, zero)
        h = r * r
        out = torch.einsum("bsf,fd->bsd", h, w2) + b2
        return out

    x = A_x
    h = x + _A_ref(_layernorm(x, axis=-1), A_wqkv, A_wo)
    h2 = h + _B_ref(_layernorm(h, axis=-1), B_w1, B_b1, B_w2, B_b2)
    return h2
```

```asm
; @launch grid=(256,1,1) block=(512,1,1) lds=163840
.amdgcn_target "amdgcn-amd-amdhsa--gfx950"
.text
.globl sequential_preLN__sliding_block__dense_activation_squared_relu__prompt_kernel
.p2align 8
.type sequential_preLN__sliding_block__dense_activation_squared_relu__prompt_kernel,@function
sequential_preLN__sliding_block__dense_activation_squared_relu__prompt_kernel:
    s_cmp_ge_u32 s2, 256
    s_cbranch_scc1 Lexit
    s_load_dwordx4 s[16:19], s[0:1], 0
    s_load_dwordx8 s[20:27], s[0:1], 16
    s_load_dwordx8 s[28:35], s[0:1], 48
    s_load_dwordx2 s[36:37], s[0:1], 80
    v_lshrrev_b32 v1, 6, v0
    v_and_b32 v0, 63, v0
    s_lshr_b32 s38, s2, 3
    v_readfirstlane_b32 s3, v1
    s_getpc_b64 s[10:11]
Lpc:
    s_and_b32 s8, s38, 7
    s_cmp_lg_u32 s8, s3
    s_cbranch_scc1 Lnopf
    s_lshl_b32 s8, s38, 10
    s_min_u32 s8, s8, Lcodeend-Lpc-1024
    s_add_u32 s10, s10, s8
    s_addc_u32 s11, s11, 0
    s_and_b32 s10, s10, -16
    v_lshlrev_b32 v2, 4, v0
    global_load_dwordx4 v[200:203], v2, s[10:11]
Lnopf:
    s_and_b32 s8, s2, 7
    s_and_b32 s7, s38, 15
    s_lshr_b32 s9, s38, 3
    s_lshl_b32 s4, s8, 2
    s_add_u32 s4, s4, s9
    s_and_b32 s5, s38, 7
    s_and_b32 s82, s3, 3
    s_cmp_lt_u32 s3, 4
    s_cbranch_scc1 Lcompute
Lloader:
    v_lshrrev_b32 v2, 3, v0
    v_and_b32 v3, 7, v0
    v_lshrrev_b32 v4, 4, v0
    v_xor_b32 v4, v4, v3
    s_lshl_b32 s13, s82, 14
    v_lshlrev_b32 v5, 10, v2
    v_add_u32 v5, s13, v5
    v_lshl_add_u32 v240, v4, 4, v5
    v_xor_b32 v4, 4, v4
    v_add_u32 v5, 8192, v5
    v_lshl_add_u32 v241, v4, 4, v5
    v_bfe_u32 v4, v0, 4, 1
    v_lshlrev_b32 v4, 2, v4
    v_xor_b32 v4, v4, v3
    v_lshlrev_b32 v4, 4, v4
    s_mul_i32 s13, s82, 49152
    v_mul_u32_u24 v5, 3072, v2
    v_add3_u32 v242, v5, v4, s13
    s_lshl_b32 s86, s4, 16
    s_lshl_b32 s87, s5, 7
    s_lshl_b32 s88, s82, 11
    s_and_b32 s89, s2, 7
    s_waitcnt lgkmcnt(0)
    s_mov_b32 s40, s16
    s_and_b32 s41, s17, 0xffff
    s_mov_b32 s42, 2097152
    s_mov_b32 s43, 0x20000
    s_mov_b32 s44, s18
    s_and_b32 s45, s19, 0xffff
    s_mov_b32 s46, 1572864
    s_mov_b32 s47, 0x20000
    s_add_u32 s14, s89, 0
    s_and_b32 s14, s14, 7
    s_mul_i32 s91, s14, 196608
    s_add_u32 s91, s91, s87
    s_lshl_b32 s13, s14, 7
    s_add_u32 s13, s13, s86
    s_add_u32 m0, s88, 98304
    s_nop 0
    buffer_load_dwordx4 v240, s[40:43], s13 offen lds
    s_add_u32 m0, s88, 99328
    s_nop 0
    buffer_load_dwordx4 v241, s[40:43], s13 offen lds
    s_add_u32 s13, s91, 1024
    s_add_u32 m0, s88, 65536
    s_nop 0
    buffer_load_dwordx4 v242, s[44:47], s13 offen lds
    s_add_u32 s13, s91, 25600
    s_add_u32 m0, s88, 66560
    s_nop 0
    buffer_load_dwordx4 v242, s[44:47], s13 offen lds
    s_add_u32 s13, s91, 2048
    s_add_u32 m0, s88, 73728
    s_nop 0
    buffer_load_dwordx4 v242, s[44:47], s13 offen lds
    s_add_u32 s13, s91, 26624
    s_add_u32 m0, s88, 74752
    s_nop 0
    buffer_load_dwordx4 v242, s[44:47], s13 offen lds
    s_add_u32 s14, s89, 1
    s_and_b32 s14, s14, 7
    s_mul_i32 s91, s14, 196608
    s_add_u32 s91, s91, s87
    s_lshl_b32 s13, s14, 7
    s_add_u32 s13, s13, s86
    s_add_u32 m0, s88, 106496
    s_nop 0
    buffer_load_dwordx4 v240, s[40:43], s13 offen lds
    s_add_u32 m0, s88, 107520
    s_nop 0
    buffer_load_dwordx4 v241, s[40:43], s13 offen lds
    s_add_u32 s13, s91, 1024
    s_add_u32 m0, s88, 81920
    s_nop 0
    buffer_load_dwordx4 v242, s[44:47], s13 offen lds
    s_add_u32 s13, s91, 25600
    s_add_u32 m0, s88, 82944
    s_nop 0
    buffer_load_dwordx4 v242, s[44:47], s13 offen lds
    s_add_u32 s13, s91, 2048
    s_add_u32 m0, s88, 90112
    s_nop 0
    buffer_load_dwordx4 v242, s[44:47], s13 offen lds
    s_add_u32 s13, s91, 26624
    s_add_u32 m0, s88, 91136
    s_nop 0
    buffer_load_dwordx4 v242, s[44:47], s13 offen lds
    s_lshr_b32 s8, s18, 7
    s_add_u32 s8, s8, s5
    s_and_b32 s8, s8, 7
    s_cmp_eq_u32 s8, 3
    s_cselect_b32 s92, 1, 0
    s_lshr_b32 s6, s4, 1
    s_and_b32 s80, s3, 1
    s_bfe_u32 s81, s3, 0x10001
    s_mov_b32 s83, 0
    s_mov_b32 s72, s36
    s_and_b32 s73, s37, 0xffff
    s_mov_b32 s74, 268435456
    s_mov_b32 s75, 0x20000
    s_mov_b32 s76, s34
    s_and_b32 s77, s35, 0xffff
    s_mov_b32 s78, 256
    s_mov_b32 s79, 0x20000
    s_mov_b32 s48, s20
    s_and_b32 s49, s21, 0xffff
    s_mov_b32 s50, 524288
    s_mov_b32 s51, 0x20000
    s_mov_b32 s52, s24
    s_and_b32 s53, s25, 0xffff
    s_mov_b32 s54, 1409024
    s_mov_b32 s55, 0x20000
    s_mov_b32 s56, s26
    s_and_b32 s57, s27, 0xffff
    s_mov_b32 s58, 2752
    s_mov_b32 s59, 0x20000
    s_mov_b32 s60, s28
    s_and_b32 s61, s29, 0xffff
    s_mov_b32 s62, 1409024
    s_mov_b32 s63, 0x20000
    s_mov_b32 s64, s30
    s_and_b32 s65, s31, 0xffff
    s_mov_b32 s66, 1024
    s_mov_b32 s67, 0x20000
    s_mov_b32 s68, s32
    s_and_b32 s69, s33, 0xffff
    s_mov_b32 s70, 2097152
    s_mov_b32 s71, 0x20000
    s_add_u32 s14, s89, 2
    s_and_b32 s14, s14, 7
    s_mul_i32 s91, s14, 196608
    s_add_u32 s91, s91, s87
    s_lshl_b32 s13, s14, 7
    s_add_u32 s13, s13, s86
    s_add_u32 m0, s88, 114688
    s_nop 0
    buffer_load_dwordx4 v240, s[40:43], s13 offen lds
    s_add_u32 m0, s88, 115712
    s_nop 0
    buffer_load_dwordx4 v241, s[40:43], s13 offen lds
    s_add_u32 s13, s91, 1024
    s_add_u32 m0, s88, 16384
    s_nop 0
    buffer_load_dwordx4 v242, s[44:47], s13 offen lds
    s_add_u32 s13, s91, 25600
    s_add_u32 m0, s88, 17408
    s_nop 0
    buffer_load_dwordx4 v242, s[44:47], s13 offen lds
    s_add_u32 s13, s91, 2048
    s_add_u32 m0, s88, 24576
    s_nop 0
    buffer_load_dwordx4 v242, s[44:47], s13 offen lds
    s_add_u32 s13, s91, 26624
    s_add_u32 m0, s88, 25600
    s_nop 0
    buffer_load_dwordx4 v242, s[44:47], s13 offen lds
    v_lshrrev_b32 v2, 2, v0
    v_lshlrev_b32 v2, 7, v2
    v_and_b32 v3, 3, v0
    v_lshl_add_u32 v2, v3, 5, v2
    s_add_u32 s13, s88, 98304
    v_add_u32 v148, s13, v2
    v_mov_b32 v150, 0
    v_mov_b32 v151, 0
    v_mov_b32 v152, 0
    v_mov_b32 v153, 0
    s_waitcnt vmcnt(12)
    s_barrier
    s_add_u32 s14, s89, 3
    s_and_b32 s14, s14, 7
    s_mul_i32 s91, s14, 196608
    s_add_u32 s91, s91, s87
    s_lshl_b32 s13, s14, 7
    s_add_u32 s13, s13, s86
    s_add_u32 m0, s88, 122880
    s_nop 0
    buffer_load_dwordx4 v240, s[40:43], s13 offen lds
    s_add_u32 m0, s88, 123904
    s_nop 0
    buffer_load_dwordx4 v241, s[40:43], s13 offen lds
    s_add_u32 s13, s91, 1024
    s_add_u32 m0, s88, 32768
    s_nop 0
    buffer_load_dwordx4 v242, s[44:47], s13 offen lds
    s_add_u32 s13, s91, 25600
    s_add_u32 m0, s88, 33792
    s_nop 0
    buffer_load_dwordx4 v242, s[44:47], s13 offen lds
    s_add_u32 s13, s91, 2048
    s_add_u32 m0, s88, 40960
    s_nop 0
    buffer_load_dwordx4 v242, s[44:47], s13 offen lds
    s_add_u32 s13, s91, 26624
    s_add_u32 m0, s88, 41984
    s_nop 0
    buffer_load_dwordx4 v242, s[44:47], s13 offen lds
    ds_read_b128 v[8:11], v148 offset:0
    ds_read_b128 v[12:15], v148 offset:16
    s_waitcnt lgkmcnt(1)
    v_lshlrev_b32 v2, 16, v8
    v_and_b32 v3, 0xffff0000, v8
    v_add_f32 v150, v150, v2
    v_add_f32 v151, v151, v3
    v_fmac_f32 v152, v2, v2
    v_fmac_f32 v153, v3, v3
    v_lshlrev_b32 v2, 16, v9
    v_and_b32 v3, 0xffff0000, v9
    v_add_f32 v150, v150, v2
    v_add_f32 v151, v151, v3
    v_fmac_f32 v152, v2, v2
    v_fmac_f32 v153, v3, v3
    v_lshlrev_b32 v2, 16, v10
    v_and_b32 v3, 0xffff0000, v10
    v_add_f32 v150, v150, v2
    v_add_f32 v151, v151, v3
    v_fmac_f32 v152, v2, v2
    v_fmac_f32 v153, v3, v3
    v_lshlrev_b32 v2, 16, v11
    v_and_b32 v3, 0xffff0000, v11
    v_add_f32 v150, v150, v2
    v_add_f32 v151, v151, v3
    v_fmac_f32 v152, v2, v2
    v_fmac_f32 v153, v3, v3
    s_waitcnt lgkmcnt(0)
    v_lshlrev_b32 v2, 16, v12
    v_and_b32 v3, 0xffff0000, v12
    v_add_f32 v150, v150, v2
    v_add_f32 v151, v151, v3
    v_fmac_f32 v152, v2, v2
    v_fmac_f32 v153, v3, v3
    v_lshlrev_b32 v2, 16, v13
    v_and_b32 v3, 0xffff0000, v13
    v_add_f32 v150, v150, v2
    v_add_f32 v151, v151, v3
    v_fmac_f32 v152, v2, v2
    v_fmac_f32 v153, v3, v3
    v_lshlrev_b32 v2, 16, v14
    v_and_b32 v3, 0xffff0000, v14
    v_add_f32 v150, v150, v2
    v_add_f32 v151, v151, v3
    v_fmac_f32 v152, v2, v2
    v_fmac_f32 v153, v3, v3
    v_lshlrev_b32 v2, 16, v15
    v_and_b32 v3, 0xffff0000, v15
    v_add_f32 v150, v150, v2
    v_add_f32 v151, v151, v3
    v_fmac_f32 v152, v2, v2
    v_fmac_f32 v153, v3, v3
    s_waitcnt vmcnt(12)
    s_barrier
    s_add_u32 s14, s89, 4
    s_and_b32 s14, s14, 7
    s_mul_i32 s91, s14, 196608
    s_add_u32 s91, s91, s87
    s_lshl_b32 s13, s14, 7
    s_add_u32 s13, s13, s86
    s_add_u32 m0, s88, 131072
    s_nop 0
    buffer_load_dwordx4 v240, s[40:43], s13 offen lds
    s_add_u32 m0, s88, 132096
    s_nop 0
    buffer_load_dwordx4 v241, s[40:43], s13 offen lds
    s_add_u32 s13, s91, 1024
    s_add_u32 m0, s88, 49152
    s_nop 0
    buffer_load_dwordx4 v242, s[44:47], s13 offen lds
    s_add_u32 s13, s91, 25600
    s_add_u32 m0, s88, 50176
    s_nop 0
    buffer_load_dwordx4 v242, s[44:47], s13 offen lds
    s_add_u32 s13, s91, 2048
    s_add_u32 m0, s88, 57344
    s_nop 0
    buffer_load_dwordx4 v242, s[44:47], s13 offen lds
    s_add_u32 s13, s91, 26624
    s_add_u32 m0, s88, 58368
    s_nop 0
    buffer_load_dwordx4 v242, s[44:47], s13 offen lds
    ds_read_b128 v[8:11], v148 offset:8192
    ds_read_b128 v[12:15], v148 offset:8208
    s_waitcnt lgkmcnt(1)
    v_lshlrev_b32 v2, 16, v8
    v_and_b32 v3, 0xffff0000, v8
    v_add_f32 v150, v150, v2
    v_add_f32 v151, v151, v3
    v_fmac_f32 v152, v2, v2
    v_fmac_f32 v153, v3, v3
    v_lshlrev_b32 v2, 16, v9
    v_and_b32 v3, 0xffff0000, v9
    v_add_f32 v150, v150, v2
    v_add_f32 v151, v151, v3
    v_fmac_f32 v152, v2, v2
    v_fmac_f32 v153, v3, v3
    v_lshlrev_b32 v2, 16, v10
    v_and_b32 v3, 0xffff0000, v10
    v_add_f32 v150, v150, v2
    v_add_f32 v151, v151, v3
    v_fmac_f32 v152, v2, v2
    v_fmac_f32 v153, v3, v3
    v_lshlrev_b32 v2, 16, v11
    v_and_b32 v3, 0xffff0000, v11
    v_add_f32 v150, v150, v2
    v_add_f32 v151, v151, v3
    v_fmac_f32 v152, v2, v2
    v_fmac_f32 v153, v3, v3
    s_waitcnt lgkmcnt(0)
    v_lshlrev_b32 v2, 16, v12
    v_and_b32 v3, 0xffff0000, v12
    v_add_f32 v150, v150, v2
    v_add_f32 v151, v151, v3
    v_fmac_f32 v152, v2, v2
    v_fmac_f32 v153, v3, v3
    v_lshlrev_b32 v2, 16, v13
    v_and_b32 v3, 0xffff0000, v13
    v_add_f32 v150, v150, v2
    v_add_f32 v151, v151, v3
    v_fmac_f32 v152, v2, v2
    v_fmac_f32 v153, v3, v3
    v_lshlrev_b32 v2, 16, v14
    v_and_b32 v3, 0xffff0000, v14
    v_add_f32 v150, v150, v2
    v_add_f32 v151, v151, v3
    v_fmac_f32 v152, v2, v2
    v_fmac_f32 v153, v3, v3
    v_lshlrev_b32 v2, 16, v15
    v_and_b32 v3, 0xffff0000, v15
    v_add_f32 v150, v150, v2
    v_add_f32 v151, v151, v3
    v_fmac_f32 v152, v2, v2
    v_fmac_f32 v153, v3, v3
    s_waitcnt vmcnt(12)
    s_barrier
    s_add_u32 s14, s89, 5
    s_and_b32 s14, s14, 7
    s_mul_i32 s91, s14, 196608
    s_add_u32 s91, s91, s87
    s_lshl_b32 s13, s14, 7
    s_add_u32 s13, s13, s86
    s_add_u32 m0, s88, 139264
    s_nop 0
    buffer_load_dwordx4 v240, s[40:43], s13 offen lds
    s_add_u32 m0, s88, 140288
    s_nop 0
    buffer_load_dwordx4 v241, s[40:43], s13 offen lds
    s_add_u32 s13, s91, 1024
    s_add_u32 m0, s88, 65536
    s_nop 0
    buffer_load_dwordx4 v242, s[44:47], s13 offen lds
    s_add_u32 s13, s91, 25600
    s_add_u32 m0, s88, 66560
    s_nop 0
    buffer_load_dwordx4 v242, s[44:47], s13 offen lds
    s_add_u32 s13, s91, 2048
    s_add_u32 m0, s88, 73728
    s_nop 0
    buffer_load_dwordx4 v242, s[44:47], s13 offen lds
    s_add_u32 s13, s91, 26624
    s_add_u32 m0, s88, 74752
    s_nop 0
    buffer_load_dwordx4 v242, s[44:47], s13 offen lds
    ds_read_b128 v[8:11], v148 offset:16384
    ds_read_b128 v[12:15], v148 offset:16400
    s_waitcnt lgkmcnt(1)
    v_lshlrev_b32 v2, 16, v8
    v_and_b32 v3, 0xffff0000, v8
    v_add_f32 v150, v150, v2
    v_add_f32 v151, v151, v3
    v_fmac_f32 v152, v2, v2
    v_fmac_f32 v153, v3, v3
    v_lshlrev_b32 v2, 16, v9
    v_and_b32 v3, 0xffff0000, v9
    v_add_f32 v150, v150, v2
    v_add_f32 v151, v151, v3
    v_fmac_f32 v152, v2, v2
    v_fmac_f32 v153, v3, v3
    v_lshlrev_b32 v2, 16, v10
    v_and_b32 v3, 0xffff0000, v10
    v_add_f32 v150, v150, v2
    v_add_f32 v151, v151, v3
    v_fmac_f32 v152, v2, v2
    v_fmac_f32 v153, v3, v3
    v_lshlrev_b32 v2, 16, v11
    v_and_b32 v3, 0xffff0000, v11
    v_add_f32 v150, v150, v2
    v_add_f32 v151, v151, v3
    v_fmac_f32 v152, v2, v2
    v_fmac_f32 v153, v3, v3
    s_waitcnt lgkmcnt(0)
    v_lshlrev_b32 v2, 16, v12
    v_and_b32 v3, 0xffff0000, v12
    v_add_f32 v150, v150, v2
    v_add_f32 v151, v151, v3
    v_fmac_f32 v152, v2, v2
    v_fmac_f32 v153, v3, v3
    v_lshlrev_b32 v2, 16, v13
    v_and_b32 v3, 0xffff0000, v13
    v_add_f32 v150, v150, v2
    v_add_f32 v151, v151, v3
    v_fmac_f32 v152, v2, v2
    v_fmac_f32 v153, v3, v3
    v_lshlrev_b32 v2, 16, v14
    v_and_b32 v3, 0xffff0000, v14
    v_add_f32 v150, v150, v2
    v_add_f32 v151, v151, v3
    v_fmac_f32 v152, v2, v2
    v_fmac_f32 v153, v3, v3
    v_lshlrev_b32 v2, 16, v15
    v_and_b32 v3, 0xffff0000, v15
    v_add_f32 v150, v150, v2
    v_add_f32 v151, v151, v3
    v_fmac_f32 v152, v2, v2
    v_fmac_f32 v153, v3, v3
    s_waitcnt vmcnt(12)
    s_barrier
    s_add_u32 s14, s89, 6
    s_and_b32 s14, s14, 7
    s_mul_i32 s91, s14, 196608
    s_add_u32 s91, s91, s87
    s_lshl_b32 s13, s14, 7
    s_add_u32 s13, s13, s86
    s_add_u32 m0, s88, 147456
    s_nop 0
    buffer_load_dwordx4 v240, s[40:43], s13 offen lds
    s_add_u32 m0, s88, 148480
    s_nop 0
    buffer_load_dwordx4 v241, s[40:43], s13 offen lds
    s_add_u32 s13, s91, 1024
    s_add_u32 m0, s88, 81920
    s_nop 0
    buffer_load_dwordx4 v242, s[44:47], s13 offen lds
    s_add_u32 s13, s91, 25600
    s_add_u32 m0, s88, 82944
    s_nop 0
    buffer_load_dwordx4 v242, s[44:47], s13 offen lds
    s_add_u32 s13, s91, 2048
    s_add_u32 m0, s88, 90112
    s_nop 0
    buffer_load_dwordx4 v242, s[44:47], s13 offen lds
    s_add_u32 s13, s91, 26624
    s_add_u32 m0, s88, 91136
    s_nop 0
    buffer_load_dwordx4 v242, s[44:47], s13 offen lds
    ds_read_b128 v[8:11], v148 offset:24576
    ds_read_b128 v[12:15], v148 offset:24592
    s_waitcnt lgkmcnt(1)
    v_lshlrev_b32 v2, 16, v8
    v_and_b32 v3, 0xffff0000, v8
    v_add_f32 v150, v150, v2
    v_add_f32 v151, v151, v3
    v_fmac_f32 v152, v2, v2
    v_fmac_f32 v153, v3, v3
    v_lshlrev_b32 v2, 16, v9
    v_and_b32 v3, 0xffff0000, v9
    v_add_f32 v150, v150, v2
    v_add_f32 v151, v151, v3
    v_fmac_f32 v152, v2, v2
    v_fmac_f32 v153, v3, v3
    v_lshlrev_b32 v2, 16, v10
    v_and_b32 v3, 0xffff0000, v10
    v_add_f32 v150, v150, v2
    v_add_f32 v151, v151, v3
    v_fmac_f32 v152, v2, v2
    v_fmac_f32 v153, v3, v3
    v_lshlrev_b32 v2, 16, v11
    v_and_b32 v3, 0xffff0000, v11
    v_add_f32 v150, v150, v2
    v_add_f32 v151, v151, v3
    v_fmac_f32 v152, v2, v2
    v_fmac_f32 v153, v3, v3
    s_waitcnt lgkmcnt(0)
    v_lshlrev_b32 v2, 16, v12
    v_and_b32 v3, 0xffff0000, v12
    v_add_f32 v150, v150, v2
    v_add_f32 v151, v151, v3
    v_fmac_f32 v152, v2, v2
    v_fmac_f32 v153, v3, v3
    v_lshlrev_b32 v2, 16, v13
    v_and_b32 v3, 0xffff0000, v13
    v_add_f32 v150, v150, v2
    v_add_f32 v151, v151, v3
    v_fmac_f32 v152, v2, v2
    v_fmac_f32 v153, v3, v3
    v_lshlrev_b32 v2, 16, v14
    v_and_b32 v3, 0xffff0000, v14
    v_add_f32 v150, v150, v2
    v_add_f32 v151, v151, v3
    v_fmac_f32 v152, v2, v2
    v_fmac_f32 v153, v3, v3
    v_lshlrev_b32 v2, 16, v15
    v_and_b32 v3, 0xffff0000, v15
    v_add_f32 v150, v150, v2
    v_add_f32 v151, v151, v3
    v_fmac_f32 v152, v2, v2
    v_fmac_f32 v153, v3, v3
    s_waitcnt vmcnt(12)
    s_barrier
    s_add_u32 s14, s89, 7
    s_and_b32 s14, s14, 7
    s_mul_i32 s91, s14, 196608
    s_add_u32 s91, s91, s87
    s_lshl_b32 s13, s14, 7
    s_add_u32 s13, s13, s86
    s_add_u32 m0, s88, 155648
    s_nop 0
    buffer_load_dwordx4 v240, s[40:43], s13 offen lds
    s_add_u32 m0, s88, 156672
    s_nop 0
    buffer_load_dwordx4 v241, s[40:43], s13 offen lds
    s_add_u32 s13, s91, 1024
    s_add_u32 m0, s88, 16384
    s_nop 0
    buffer_load_dwordx4 v242, s[44:47], s13 offen lds
    s_add_u32 s13, s91, 25600
    s_add_u32 m0, s88, 17408
    s_nop 0
    buffer_load_dwordx4 v242, s[44:47], s13 offen lds
    s_add_u32 s13, s91, 2048
    s_add_u32 m0, s88, 24576
    s_nop 0
    buffer_load_dwordx4 v242, s[44:47], s13 offen lds
    s_add_u32 s13, s91, 26624
    s_add_u32 m0, s88, 25600
    s_nop 0
    buffer_load_dwordx4 v242, s[44:47], s13 offen lds
    ds_read_b128 v[8:11], v148 offset:32768
    ds_read_b128 v[12:15], v148 offset:32784
    s_waitcnt lgkmcnt(1)
    v_lshlrev_b32 v2, 16, v8
    v_and_b32 v3, 0xffff0000, v8
    v_add_f32 v150, v150, v2
    v_add_f32 v151, v151, v3
    v_fmac_f32 v152, v2, v2
    v_fmac_f32 v153, v3, v3
    v_lshlrev_b32 v2, 16, v9
    v_and_b32 v3, 0xffff0000, v9
    v_add_f32 v150, v150, v2
    v_add_f32 v151, v151, v3
    v_fmac_f32 v152, v2, v2
    v_fmac_f32 v153, v3, v3
    v_lshlrev_b32 v2, 16, v10
    v_and_b32 v3, 0xffff0000, v10
    v_add_f32 v150, v150, v2
    v_add_f32 v151, v151, v3
    v_fmac_f32 v152, v2, v2
    v_fmac_f32 v153, v3, v3
    v_lshlrev_b32 v2, 16, v11
    v_and_b32 v3, 0xffff0000, v11
    v_add_f32 v150, v150, v2
    v_add_f32 v151, v151, v3
    v_fmac_f32 v152, v2, v2
    v_fmac_f32 v153, v3, v3
    s_waitcnt lgkmcnt(0)
    v_lshlrev_b32 v2, 16, v12
    v_and_b32 v3, 0xffff0000, v12
    v_add_f32 v150, v150, v2
    v_add_f32 v151, v151, v3
    v_fmac_f32 v152, v2, v2
    v_fmac_f32 v153, v3, v3
    v_lshlrev_b32 v2, 16, v13
    v_and_b32 v3, 0xffff0000, v13
    v_add_f32 v150, v150, v2
    v_add_f32 v151, v151, v3
    v_fmac_f32 v152, v2, v2
    v_fmac_f32 v153, v3, v3
    v_lshlrev_b32 v2, 16, v14
    v_and_b32 v3, 0xffff0000, v14
    v_add_f32 v150, v150, v2
    v_add_f32 v151, v151, v3
    v_fmac_f32 v152, v2, v2
    v_fmac_f32 v153, v3, v3
    v_lshlrev_b32 v2, 16, v15
    v_and_b32 v3, 0xffff0000, v15
    v_add_f32 v150, v150, v2
    v_add_f32 v151, v151, v3
    v_fmac_f32 v152, v2, v2
    v_fmac_f32 v153, v3, v3
    s_waitcnt vmcnt(12)
    s_barrier
    s_add_u32 s14, s89, 0
    s_and_b32 s14, s14, 7
    s_mul_i32 s91, s14, 196608
    s_add_u32 s91, s91, s87
    s_add_u32 s13, s91, 0
    s_add_u32 m0, s88, 32768
    s_nop 0
    buffer_load_dwordx4 v242, s[44:47], s13 offen lds
    s_add_u32 s13, s91, 24576
    s_add_u32 m0, s88, 33792
    s_nop 0
    buffer_load_dwordx4 v242, s[44:47], s13 offen lds
    s_add_u32 s14, s89, 1
    s_and_b32 s14, s14, 7
    s_mul_i32 s91, s14, 196608
    s_add_u32 s91, s91, s87
    s_add_u32 s13, s91, 0
    s_add_u32 m0, s88, 40960
    s_nop 0
    buffer_load_dwordx4 v242, s[44:47], s13 offen lds
    s_add_u32 s13, s91, 24576
    s_add_u32 m0, s88, 41984
    s_nop 0
    buffer_load_dwordx4 v242, s[44:47], s13 offen lds
    ds_read_b128 v[8:11], v148 offset:40960
    ds_read_b128 v[12:15], v148 offset:40976
    s_waitcnt lgkmcnt(1)
    v_lshlrev_b32 v2, 16, v8
    v_and_b32 v3, 0xffff0000, v8
    v_add_f32 v150, v150, v2
    v_add_f32 v151, v151, v3
    v_fmac_f32 v152, v2, v2
    v_fmac_f32 v153, v3, v3
    v_lshlrev_b32 v2, 16, v9
    v_and_b32 v3, 0xffff0000, v9
    v_add_f32 v150, v150, v2
    v_add_f32 v151, v151, v3
    v_fmac_f32 v152, v2, v2
    v_fmac_f32 v153, v3, v3
    v_lshlrev_b32 v2, 16, v10
    v_and_b32 v3, 0xffff0000, v10
    v_add_f32 v150, v150, v2
    v_add_f32 v151, v151, v3
    v_fmac_f32 v152, v2, v2
    v_fmac_f32 v153, v3, v3
    v_lshlrev_b32 v2, 16, v11
    v_and_b32 v3, 0xffff0000, v11
    v_add_f32 v150, v150, v2
    v_add_f32 v151, v151, v3
    v_fmac_f32 v152, v2, v2
    v_fmac_f32 v153, v3, v3
    s_waitcnt lgkmcnt(0)
    v_lshlrev_b32 v2, 16, v12
    v_and_b32 v3, 0xffff0000, v12
    v_add_f32 v150, v150, v2
    v_add_f32 v151, v151, v3
    v_fmac_f32 v152, v2, v2
    v_fmac_f32 v153, v3, v3
    v_lshlrev_b32 v2, 16, v13
    v_and_b32 v3, 0xffff0000, v13
    v_add_f32 v150, v150, v2
    v_add_f32 v151, v151, v3
    v_fmac_f32 v152, v2, v2
    v_fmac_f32 v153, v3, v3
    v_lshlrev_b32 v2, 16, v14
    v_and_b32 v3, 0xffff0000, v14
    v_add_f32 v150, v150, v2
    v_add_f32 v151, v151, v3
    v_fmac_f32 v152, v2, v2
    v_fmac_f32 v153, v3, v3
    v_lshlrev_b32 v2, 16, v15
    v_and_b32 v3, 0xffff0000, v15
    v_add_f32 v150, v150, v2
    v_add_f32 v151, v151, v3
    v_fmac_f32 v152, v2, v2
    v_fmac_f32 v153, v3, v3
    s_waitcnt vmcnt(10)
    s_barrier
    s_add_u32 s14, s89, 2
    s_and_b32 s14, s14, 7
    s_mul_i32 s91, s14, 196608
    s_add_u32 s91, s91, s87
    s_add_u32 s13, s91, 0
    s_add_u32 m0, s88, 49152
    s_nop 0
    buffer_load_dwordx4 v242, s[44:47], s13 offen lds
    s_add_u32 s13, s91, 24576
    s_add_u32 m0, s88, 50176
    s_nop 0
    buffer_load_dwordx4 v242, s[44:47], s13 offen lds
    s_add_u32 s14, s89, 3
    s_and_b32 s14, s14, 7
    s_mul_i32 s91, s14, 196608
    s_add_u32 s91, s91, s87
    s_add_u32 s13, s91, 0
    s_add_u32 m0, s88, 57344
    s_nop 0
    buffer_load_dwordx4 v242, s[44:47], s13 offen lds
    s_add_u32 s13, s91, 24576
    s_add_u32 m0, s88, 58368
    s_nop 0
    buffer_load_dwordx4 v242, s[44:47], s13 offen lds
    ds_read_b128 v[8:11], v148 offset:49152
    ds_read_b128 v[12:15], v148 offset:49168
    s_waitcnt lgkmcnt(1)
    v_lshlrev_b32 v2, 16, v8
    v_and_b32 v3, 0xffff0000, v8
    v_add_f32 v150, v150, v2
    v_add_f32 v151, v151, v3
    v_fmac_f32 v152, v2, v2
    v_fmac_f32 v153, v3, v3
    v_lshlrev_b32 v2, 16, v9
    v_and_b32 v3, 0xffff0000, v9
    v_add_f32 v150, v150, v2
    v_add_f32 v151, v151, v3
    v_fmac_f32 v152, v2, v2
    v_fmac_f32 v153, v3, v3
    v_lshlrev_b32 v2, 16, v10
    v_and_b32 v3, 0xffff0000, v10
    v_add_f32 v150, v150, v2
    v_add_f32 v151, v151, v3
    v_fmac_f32 v152, v2, v2
    v_fmac_f32 v153, v3, v3
    v_lshlrev_b32 v2, 16, v11
    v_and_b32 v3, 0xffff0000, v11
    v_add_f32 v150, v150, v2
    v_add_f32 v151, v151, v3
    v_fmac_f32 v152, v2, v2
    v_fmac_f32 v153, v3, v3
    s_waitcnt lgkmcnt(0)
    v_lshlrev_b32 v2, 16, v12
    v_and_b32 v3, 0xffff0000, v12
    v_add_f32 v150, v150, v2
    v_add_f32 v151, v151, v3
    v_fmac_f32 v152, v2, v2
    v_fmac_f32 v153, v3, v3
    v_lshlrev_b32 v2, 16, v13
    v_and_b32 v3, 0xffff0000, v13
    v_add_f32 v150, v150, v2
    v_add_f32 v151, v151, v3
    v_fmac_f32 v152, v2, v2
    v_fmac_f32 v153, v3, v3
    v_lshlrev_b32 v2, 16, v14
    v_and_b32 v3, 0xffff0000, v14
    v_add_f32 v150, v150, v2
    v_add_f32 v151, v151, v3
    v_fmac_f32 v152, v2, v2
    v_fmac_f32 v153, v3, v3
    v_lshlrev_b32 v2, 16, v15
    v_and_b32 v3, 0xffff0000, v15
    v_add_f32 v150, v150, v2
    v_add_f32 v151, v151, v3
    v_fmac_f32 v152, v2, v2
    v_fmac_f32 v153, v3, v3
    s_waitcnt vmcnt(8)
    s_barrier
    s_add_u32 s14, s89, 4
    s_and_b32 s14, s14, 7
    s_mul_i32 s91, s14, 196608
    s_add_u32 s91, s91, s87
    s_add_u32 s13, s91, 0
    s_add_u32 m0, s88, 65536
    s_nop 0
    buffer_load_dwordx4 v242, s[44:47], s13 offen lds
    s_add_u32 s13, s91, 24576
    s_add_u32 m0, s88, 66560
    s_nop 0
    buffer_load_dwordx4 v242, s[44:47], s13 offen lds
    s_add_u32 s14, s89, 5
    s_and_b32 s14, s14, 7
    s_mul_i32 s91, s14, 196608
    s_add_u32 s91, s91, s87
    s_add_u32 s13, s91, 0
    s_add_u32 m0, s88, 73728
    s_nop 0
    buffer_load_dwordx4 v242, s[44:47], s13 offen lds
    s_add_u32 s13, s91, 24576
    s_add_u32 m0, s88, 74752
    s_nop 0
    buffer_load_dwordx4 v242, s[44:47], s13 offen lds
    s_add_u32 s14, s89, 6
    s_and_b32 s14, s14, 7
    s_mul_i32 s91, s14, 196608
    s_add_u32 s91, s91, s87
    s_add_u32 s13, s91, 0
    s_add_u32 m0, s88, 81920
    s_nop 0
    buffer_load_dwordx4 v242, s[44:47], s13 offen lds
    s_add_u32 s13, s91, 24576
    s_add_u32 m0, s88, 82944
    s_nop 0
    buffer_load_dwordx4 v242, s[44:47], s13 offen lds
    s_add_u32 s14, s89, 7
    s_and_b32 s14, s14, 7
    s_mul_i32 s91, s14, 196608
    s_add_u32 s91, s91, s87
    s_add_u32 s13, s91, 0
    s_add_u32 m0, s88, 90112
    s_nop 0
    buffer_load_dwordx4 v242, s[44:47], s13 offen lds
    s_add_u32 s13, s91, 24576
    s_add_u32 m0, s88, 91136
    s_nop 0
    buffer_load_dwordx4 v242, s[44:47], s13 offen lds
    ds_read_b128 v[8:11], v148 offset:57344
    ds_read_b128 v[12:15], v148 offset:57360
    s_waitcnt lgkmcnt(1)
    v_lshlrev_b32 v2, 16, v8
    v_and_b32 v3, 0xffff0000, v8
    v_add_f32 v150, v150, v2
    v_add_f32 v151, v151, v3
    v_fmac_f32 v152, v2, v2
    v_fmac_f32 v153, v3, v3
    v_lshlrev_b32 v2, 16, v9
    v_and_b32 v3, 0xffff0000, v9
    v_add_f32 v150, v150, v2
    v_add_f32 v151, v151, v3
    v_fmac_f32 v152, v2, v2
    v_fmac_f32 v153, v3, v3
    v_lshlrev_b32 v2, 16, v10
    v_and_b32 v3, 0xffff0000, v10
    v_add_f32 v150, v150, v2
    v_add_f32 v151, v151, v3
    v_fmac_f32 v152, v2, v2
    v_fmac_f32 v153, v3, v3
    v_lshlrev_b32 v2, 16, v11
    v_and_b32 v3, 0xffff0000, v11
    v_add_f32 v150, v150, v2
    v_add_f32 v151, v151, v3
    v_fmac_f32 v152, v2, v2
    v_fmac_f32 v153, v3, v3
    s_waitcnt lgkmcnt(0)
    v_lshlrev_b32 v2, 16, v12
    v_and_b32 v3, 0xffff0000, v12
    v_add_f32 v150, v150, v2
    v_add_f32 v151, v151, v3
    v_fmac_f32 v152, v2, v2
    v_fmac_f32 v153, v3, v3
    v_lshlrev_b32 v2, 16, v13
    v_and_b32 v3, 0xffff0000, v13
    v_add_f32 v150, v150, v2
    v_add_f32 v151, v151, v3
    v_fmac_f32 v152, v2, v2
    v_fmac_f32 v153, v3, v3
    v_lshlrev_b32 v2, 16, v14
    v_and_b32 v3, 0xffff0000, v14
    v_add_f32 v150, v150, v2
    v_add_f32 v151, v151, v3
    v_fmac_f32 v152, v2, v2
    v_fmac_f32 v153, v3, v3
    v_lshlrev_b32 v2, 16, v15
    v_and_b32 v3, 0xffff0000, v15
    v_add_f32 v150, v150, v2
    v_add_f32 v151, v151, v3
    v_fmac_f32 v152, v2, v2
    v_fmac_f32 v153, v3, v3
    v_add_f32 v150, v150, v151
    v_add_f32 v152, v152, v153
    s_nop 0
    v_add_f32_dpp v150, v150, v150 quad_perm:[1,0,3,2] row_mask:0xf bank_mask:0xf
    v_add_f32_dpp v152, v152, v152 quad_perm:[1,0,3,2] row_mask:0xf bank_mask:0xf
    s_nop 0
    v_add_f32_dpp v150, v150, v150 quad_perm:[2,3,0,1] row_mask:0xf bank_mask:0xf
    v_add_f32_dpp v152, v152, v152 quad_perm:[2,3,0,1] row_mask:0xf bank_mask:0xf
    v_mul_f32 v150, 0x3b000000, v150
    v_mul_f32 v152, 0x3b000000, v152
    v_fma_f32 v152, -v150, v150, v152
    v_max_f32 v152, 0, v152
    v_add_f32 v152, 0x3727c5ac, v152
    v_rsq_f32 v152, v152
    v_and_b32 v3, 3, v0
    v_cmp_eq_u32 vcc, 0, v3
    v_mul_f32 v150, v150, v152
    s_nop 0
    v_cndmask_b32 v150, v150, v152, vcc
    v_lshrrev_b32 v2, 2, v0
    v_lshlrev_b32 v2, 2, v2
    v_lshl_add_u32 v2, v3, 8, v2
    s_lshl_b32 s13, s82, 6
    v_add_u32 v2, s13, v2
    s_mov_b32 exec_lo, 0x33333333
    s_mov_b32 exec_hi, 0x33333333
    ds_write_b32 v2, v150 offset:0
    s_mov_b64 exec, -1
    s_waitcnt lgkmcnt(0)
    s_barrier
    v_and_b32 v2, 31, v0
    v_bfe_u32 v3, v0, 1, 3
    v_lshrrev_b32 v4, 5, v0
    v_xor_b32 v3, v3, v4
    s_lshl_b32 s13, s80, 12
    s_add_u32 s13, s13, 98304
    v_lshlrev_b32 v2, 7, v2
    v_add_u32 v2, s13, v2
    v_xor_b32 v4, 0, v3
    v_lshl_add_u32 v140, v4, 4, v2
    v_xor_b32 v4, 2, v3
    v_lshl_add_u32 v141, v4, 4, v2
    v_xor_b32 v4, 4, v3
    v_lshl_add_u32 v142, v4, 4, v2
    v_xor_b32 v4, 6, v3
    v_lshl_add_u32 v143, v4, 4, v2
    v_lshrrev_b32 v144, 5, v0
    v_mul_u32_u24 v144, 8, v144
    v_bfe_u32 v2, v0, 2, 2
    v_add_u32 v144, v144, v2
    v_mul_u32_u24 v144, 128, v144
    v_bfe_u32 v2, v0, 3, 1
    v_xor_b32 v2, s81, v2
    v_lshl_add_u32 v144, v2, 6, v144
    v_bfe_u32 v2, v0, 4, 1
    v_lshl_add_u32 v144, v2, 5, v144
    v_and_b32 v2, 3, v0
    v_lshl_add_u32 v144, v2, 3, v144
    v_add_u32 v144, 32768, v144
    v_mov_b32 v138, 0x3f803f80
    v_mov_b32 v128, 0
    v_mov_b32 v129, 0
    v_mov_b32 v16, 0
    v_mov_b32 v17, 0
    v_mov_b32 v18, 0
    v_mov_b32 v19, 0
    v_mov_b32 v20, 0
    v_mov_b32 v21, 0
    v_mov_b32 v22, 0
    v_mov_b32 v23, 0
    v_mov_b32 v24, 0
    v_mov_b32 v25, 0
    v_mov_b32 v26, 0
    v_mov_b32 v27, 0
    v_mov_b32 v28, 0
    v_mov_b32 v29, 0
    v_mov_b32 v30, 0
    v_mov_b32 v31, 0
    v_mov_b32 v2, 520
    ds_read_b32 v3, v2
    v_and_b32 v9, 31, v0
    v_lshlrev_b32 v9, 2, v9
    s_lshl_b32 s13, s80, 7
    v_add_u32 v9, s13, v9
    ds_read_b32 v148, v9 offset:0
    ds_read_b32 v150, v9 offset:256
    s_waitcnt lgkmcnt(0)
    v_readfirstlane_b32 s83, v3
    v_mul_f32 v148, 0x3eb8aa3b, v148
    v_mul_f32 v150, 0x3eb8aa3b, v150
    s_waitcnt vmcnt(0)
    v_mov_b32 v2, 512
    v_mov_b32 v3, 1
    s_mov_b64 exec, 1
    ds_add_u32 v2, v3
    s_mov_b64 exec, -1
    v_mov_b32 v2, 512
    s_mov_b32 s8, 0
Llw1:
    ds_read_b32 v3, v2
    s_add_u32 s8, s8, 1
    s_waitcnt lgkmcnt(0)
    v_readfirstlane_b32 s9, v3
    s_cmp_gt_u32 s8, 1600000
    s_cbranch_scc1 Llwd2
    s_cmp_lt_u32 s9, 4
    s_cbranch_scc1 Llw1
Llwd2:
    v_lshlrev_b32 v245, 7, v0
    s_cmp_ge_u32 s82, 2
    s_cbranch_scc1 L3
    s_lshl_b32 s26, s38, 14
    s_lshl_b32 s13, s82, 13
    s_add_u32 s26, s26, s13
    s_add_u32 s13, s26, 0
    buffer_load_dword v239, v245, s[48:51], s13 offen
    s_branch L4
L3:
L4:
    ds_read_b128 v[64:67], v140 offset:0
    ds_read_b64_tr_b16 v[80:81], v144 offset:0
    ds_read_b64_tr_b16 v[82:83], v144 offset:512
    ds_read_b128 v[68:71], v141 offset:0
    ds_read_b64_tr_b16 v[84:85], v144 offset:2048
    ds_read_b64_tr_b16 v[86:87], v144 offset:2560
    ds_read_b128 v[72:75], v142 offset:0
    ds_read_b64_tr_b16 v[88:89], v144 offset:4096
    ds_read_b64_tr_b16 v[90:91], v144 offset:4608
    ds_read_b128 v[76:79], v143 offset:0
    ds_read_b64_tr_b16 v[92:93], v144 offset:6144
    ds_read_b64_tr_b16 v[94:95], v144 offset:6656
    s_waitcnt lgkmcnt(0)
    v_mfma_f32_32x32x16_bf16 v[16:31], v[80:83], v[64:67], v[16:31]
    ds_read_b128 v[96:99], v140 offset:8192
    ds_read_b64_tr_b16 v[112:113], v144 offset:8192
    ds_read_b64_tr_b16 v[114:115], v144 offset:8704
    v_mfma_f32_32x32x16_bf16 v[16:31], v[84:87], v[68:71], v[16:31]
    ds_read_b128 v[100:103], v141 offset:8192
    ds_read_b64_tr_b16 v[116:117], v144 offset:10240
    ds_read_b64_tr_b16 v[118:119], v144 offset:10752
    v_mfma_f32_32x32x16_bf16 v[16:31], v[88:91], v[72:75], v[16:31]
    ds_read_b128 v[104:107], v142 offset:8192
    ds_read_b64_tr_b16 v[120:121], v144 offset:12288
    ds_read_b64_tr_b16 v[122:123], v144 offset:12800
    v_mfma_f32_32x32x16_bf16 v[16:31], v[92:95], v[76:79], v[16:31]
    ds_read_b128 v[108:111], v143 offset:8192
    ds_read_b64_tr_b16 v[124:125], v144 offset:14336
    ds_read_b64_tr_b16 v[126:127], v144 offset:14848
    v_dot2c_f32_bf16 v128, v80, v138
    v_dot2c_f32_bf16 v129, v81, v138
    v_dot2c_f32_bf16 v128, v82, v138
    v_dot2c_f32_bf16 v129, v83, v138
    v_dot2c_f32_bf16 v128, v84, v138
    v_dot2c_f32_bf16 v129, v85, v138
    v_dot2c_f32_bf16 v128, v86, v138
    v_dot2c_f32_bf16 v129, v87, v138
    v_dot2c_f32_bf16 v128, v88, v138
    v_dot2c_f32_bf16 v129, v89, v138
    v_dot2c_f32_bf16 v128, v90, v138
    v_dot2c_f32_bf16 v129, v91, v138
    v_dot2c_f32_bf16 v128, v92, v138
    v_dot2c_f32_bf16 v129, v93, v138
    v_dot2c_f32_bf16 v128, v94, v138
    v_dot2c_f32_bf16 v129, v95, v138
    s_waitcnt lgkmcnt(0)
    v_mfma_f32_32x32x16_bf16 v[16:31], v[112:115], v[96:99], v[16:31]
    ds_read_b128 v[64:67], v140 offset:16384
    ds_read_b64_tr_b16 v[80:81], v144 offset:16384
    ds_read_b64_tr_b16 v[82:83], v144 offset:16896
    v_mfma_f32_32x32x16_bf16 v[16:31], v[116:119], v[100:103], v[16:31]
    ds_read_b128 v[68:71], v141 offset:16384
    ds_read_b64_tr_b16 v[84:85], v144 offset:18432
    ds_read_b64_tr_b16 v[86:87], v144 offset:18944
    v_mfma_f32_32x32x16_bf16 v[16:31], v[120:123], v[104:107], v[16:31]
    ds_read_b128 v[72:75], v142 offset:16384
    ds_read_b64_tr_b16 v[88:89], v144 offset:20480
    ds_read_b64_tr_b16 v[90:91], v144 offset:20992
    v_mfma_f32_32x32x16_bf16 v[16:31], v[124:127], v[108:111], v[16:31]
    ds_read_b128 v[76:79], v143 offset:16384
    ds_read_b64_tr_b16 v[92:93], v144 offset:22528
    ds_read_b64_tr_b16 v[94:95], v144 offset:23040
    v_dot2c_f32_bf16 v128, v112, v138
    v_dot2c_f32_bf16 v129, v113, v138
    v_dot2c_f32_bf16 v128, v114, v138
    v_dot2c_f32_bf16 v129, v115, v138
    v_dot2c_f32_bf16 v128, v116, v138
    v_dot2c_f32_bf16 v129, v117, v138
    v_dot2c_f32_bf16 v128, v118, v138
    v_dot2c_f32_bf16 v129, v119, v138
    v_dot2c_f32_bf16 v128, v120, v138
    v_dot2c_f32_bf16 v129, v121, v138
    v_dot2c_f32_bf16 v128, v122, v138
    v_dot2c_f32_bf16 v129, v123, v138
    v_dot2c_f32_bf16 v128, v124, v138
    v_dot2c_f32_bf16 v129, v125, v138
    v_dot2c_f32_bf16 v128, v126, v138
    v_dot2c_f32_bf16 v129, v127, v138
    s_waitcnt lgkmcnt(0)
    v_mfma_f32_32x32x16_bf16 v[16:31], v[80:83], v[64:67], v[16:31]
    ds_read_b128 v[96:99], v140 offset:24576
    ds_read_b64_tr_b16 v[112:113], v144 offset:24576
    ds_read_b64_tr_b16 v[114:115], v144 offset:25088
    v_mfma_f32_32x32x16_bf16 v[16:31], v[84:87], v[68:71], v[16:31]
    ds_read_b128 v[100:103], v141 offset:24576
    ds_read_b64_tr_b16 v[116:117], v144 offset:26624
    ds_read_b64_tr_b16 v[118:119], v144 offset:27136
    v_mfma_f32_32x32x16_bf16 v[16:31], v[88:91], v[72:75], v[16:31]
    ds_read_b128 v[104:107], v142 offset:24576
    ds_read_b64_tr_b16 v[120:121], v144 offset:28672
    ds_read_b64_tr_b16 v[122:123], v144 offset:29184
    v_mfma_f32_32x32x16_bf16 v[16:31], v[92:95], v[76:79], v[16:31]
    ds_read_b128 v[108:111], v143 offset:24576
    ds_read_b64_tr_b16 v[124:125], v144 offset:30720
    ds_read_b64_tr_b16 v[126:127], v144 offset:31232
    v_dot2c_f32_bf16 v128, v80, v138
    v_dot2c_f32_bf16 v129, v81, v138
    v_dot2c_f32_bf16 v128, v82, v138
    v_dot2c_f32_bf16 v129, v83, v138
    v_dot2c_f32_bf16 v128, v84, v138
    v_dot2c_f32_bf16 v129, v85, v138
    v_dot2c_f32_bf16 v128, v86, v138
    v_dot2c_f32_bf16 v129, v87, v138
    v_dot2c_f32_bf16 v128, v88, v138
    v_dot2c_f32_bf16 v129, v89, v138
    v_dot2c_f32_bf16 v128, v90, v138
    v_dot2c_f32_bf16 v129, v91, v138
    v_dot2c_f32_bf16 v128, v92, v138
    v_dot2c_f32_bf16 v129, v93, v138
    v_dot2c_f32_bf16 v128, v94, v138
    v_dot2c_f32_bf16 v129, v95, v138
    s_waitcnt lgkmcnt(0)
    v_mfma_f32_32x32x16_bf16 v[16:31], v[112:115], v[96:99], v[16:31]
    ds_read_b128 v[64:67], v140 offset:32768
    ds_read_b64_tr_b16 v[80:81], v144 offset:32768
    ds_read_b64_tr_b16 v[82:83], v144 offset:33280
    v_mfma_f32_32x32x16_bf16 v[16:31], v[116:119], v[100:103], v[16:31]
    ds_read_b128 v[68:71], v141 offset:32768
    ds_read_b64_tr_b16 v[84:85], v144 offset:34816
    ds_read_b64_tr_b16 v[86:87], v144 offset:35328
    v_mfma_f32_32x32x16_bf16 v[16:31], v[120:123], v[104:107], v[16:31]
    ds_read_b128 v[72:75], v142 offset:32768
    ds_read_b64_tr_b16 v[88:89], v144 offset:36864
    ds_read_b64_tr_b16 v[90:91], v144 offset:37376
    v_mfma_f32_32x32x16_bf16 v[16:31], v[124:127], v[108:111], v[16:31]
    ds_read_b128 v[76:79], v143 offset:32768
    ds_read_b64_tr_b16 v[92:93], v144 offset:38912
    ds_read_b64_tr_b16 v[94:95], v144 offset:39424
    v_dot2c_f32_bf16 v128, v112, v138
    v_dot2c_f32_bf16 v129, v113, v138
    v_dot2c_f32_bf16 v128, v114, v138
    v_dot2c_f32_bf16 v129, v115, v138
    v_dot2c_f32_bf16 v128, v116, v138
    v_dot2c_f32_bf16 v129, v117, v138
    v_dot2c_f32_bf16 v128, v118, v138
    v_dot2c_f32_bf16 v129, v119, v138
    v_dot2c_f32_bf16 v128, v120, v138
    v_dot2c_f32_bf16 v129, v121, v138
    v_dot2c_f32_bf16 v128, v122, v138
    v_dot2c_f32_bf16 v129, v123, v138
    v_dot2c_f32_bf16 v128, v124, v138
    v_dot2c_f32_bf16 v129, v125, v138
    v_dot2c_f32_bf16 v128, v126, v138
    v_dot2c_f32_bf16 v129, v127, v138
    s_waitcnt lgkmcnt(0)
    v_mfma_f32_32x32x16_bf16 v[16:31], v[80:83], v[64:67], v[16:31]
    ds_read_b128 v[96:99], v140 offset:40960
    ds_read_b64_tr_b16 v[112:113], v144 offset:40960
    ds_read_b64_tr_b16 v[114:115], v144 offset:41472
    v_mfma_f32_32x32x16_bf16 v[16:31], v[84:87], v[68:71], v[16:31]
    ds_read_b128 v[100:103], v141 offset:40960
    ds_read_b64_tr_b16 v[116:117], v144 offset:43008
    ds_read_b64_tr_b16 v[118:119], v144 offset:43520
    v_mfma_f32_32x32x16_bf16 v[16:31], v[88:91], v[72:75], v[16:31]
    ds_read_b128 v[104:107], v142 offset:40960
    ds_read_b64_tr_b16 v[120:121], v144 offset:45056
    ds_read_b64_tr_b16 v[122:123], v144 offset:45568
    v_mfma_f32_32x32x16_bf16 v[16:31], v[92:95], v[76:79], v[16:31]
    ds_read_b128 v[108:111], v143 offset:40960
    ds_read_b64_tr_b16 v[124:125], v144 offset:47104
    ds_read_b64_tr_b16 v[126:127], v144 offset:47616
    v_dot2c_f32_bf16 v128, v80, v138
    v_dot2c_f32_bf16 v129, v81, v138
    v_dot2c_f32_bf16 v128, v82, v138
    v_dot2c_f32_bf16 v129, v83, v138
    v_dot2c_f32_bf16 v128, v84, v138
    v_dot2c_f32_bf16 v129, v85, v138
    v_dot2c_f32_bf16 v128, v86, v138
    v_dot2c_f32_bf16 v129, v87, v138
    v_dot2c_f32_bf16 v128, v88, v138
    v_dot2c_f32_bf16 v129, v89, v138
    v_dot2c_f32_bf16 v128, v90, v138
    v_dot2c_f32_bf16 v129, v91, v138
    v_dot2c_f32_bf16 v128, v92, v138
    v_dot2c_f32_bf16 v129, v93, v138
    v_dot2c_f32_bf16 v128, v94, v138
    v_dot2c_f32_bf16 v129, v95, v138
    s_waitcnt lgkmcnt(0)
    v_mfma_f32_32x32x16_bf16 v[16:31], v[112:115], v[96:99], v[16:31]
    ds_read_b128 v[64:67], v140 offset:49152
    ds_read_b64_tr_b16 v[80:81], v144 offset:49152
    ds_read_b64_tr_b16 v[82:83], v144 offset:49664
    v_mfma_f32_32x32x16_bf16 v[16:31], v[116:119], v[100:103], v[16:31]
    ds_read_b128 v[68:71], v141 offset:49152
    ds_read_b64_tr_b16 v[84:85], v144 offset:51200
    ds_read_b64_tr_b16 v[86:87], v144 offset:51712
    v_mfma_f32_32x32x16_bf16 v[16:31], v[120:123], v[104:107], v[16:31]
    ds_read_b128 v[72:75], v142 offset:49152
    ds_read_b64_tr_b16 v[88:89], v144 offset:53248
    ds_read_b64_tr_b16 v[90:91], v144 offset:53760
    v_mfma_f32_32x32x16_bf16 v[16:31], v[124:127], v[108:111], v[16:31]
    ds_read_b128 v[76:79], v143 offset:49152
    ds_read_b64_tr_b16 v[92:93], v144 offset:55296
    ds_read_b64_tr_b16 v[94:95], v144 offset:55808
    v_dot2c_f32_bf16 v128, v112, v138
    v_dot2c_f32_bf16 v129, v113, v138
    v_dot2c_f32_bf16 v128, v114, v138
    v_dot2c_f32_bf16 v129, v115, v138
    v_dot2c_f32_bf16 v128, v116, v138
    v_dot2c_f32_bf16 v129, v117, v138
    v_dot2c_f32_bf16 v128, v118, v138
    v_dot2c_f32_bf16 v129, v119, v138
    v_dot2c_f32_bf16 v128, v120, v138
    v_dot2c_f32_bf16 v129, v121, v138
    v_dot2c_f32_bf16 v128, v122, v138
    v_dot2c_f32_bf16 v129, v123, v138
    v_dot2c_f32_bf16 v128, v124, v138
    v_dot2c_f32_bf16 v129, v125, v138
    v_dot2c_f32_bf16 v128, v126, v138
    v_dot2c_f32_bf16 v129, v127, v138
    s_waitcnt lgkmcnt(0)
    v_mfma_f32_32x32x16_bf16 v[16:31], v[80:83], v[64:67], v[16:31]
    ds_read_b128 v[96:99], v140 offset:57344
    ds_read_b64_tr_b16 v[112:113], v144 offset:57344
    ds_read_b64_tr_b16 v[114:115], v144 offset:57856
    v_mfma_f32_32x32x16_bf16 v[16:31], v[84:87], v[68:71], v[16:31]
    ds_read_b128 v[100:103], v141 offset:57344
    ds_read_b64_tr_b16 v[116:117], v144 offset:59392
    ds_read_b64_tr_b16 v[118:119], v144 offset:59904
    v_mfma_f32_32x32x16_bf16 v[16:31], v[88:91], v[72:75], v[16:31]
    ds_read_b128 v[104:107], v142 offset:57344
    ds_read_b64_tr_b16 v[120:121], v144 offset:61440
    ds_read_b64_tr_b16 v[122:123], v144 offset:61952
    v_mfma_f32_32x32x16_bf16 v[16:31], v[92:95], v[76:79], v[16:31]
    ds_read_b128 v[108:111], v143 offset:57344
    ds_read_b64_tr_b16 v[124:125], v144 offset:63488
    ds_read_b64_tr_b16 v[126:127], v144 offset:64000
    v_dot2c_f32_bf16 v128, v80, v138
    v_dot2c_f32_bf16 v129, v81, v138
    v_dot2c_f32_bf16 v128, v82, v138
    v_dot2c_f32_bf16 v129, v83, v138
    v_dot2c_f32_bf16 v128, v84, v138
    v_dot2c_f32_bf16 v129, v85, v138
    v_dot2c_f32_bf16 v128, v86, v138
    v_dot2c_f32_bf16 v129, v87, v138
    v_dot2c_f32_bf16 v128, v88, v138
    v_dot2c_f32_bf16 v129, v89, v138
    v_dot2c_f32_bf16 v128, v90, v138
    v_dot2c_f32_bf16 v129, v91, v138
    v_dot2c_f32_bf16 v128, v92, v138
    v_dot2c_f32_bf16 v129, v93, v138
    v_dot2c_f32_bf16 v128, v94, v138
    v_dot2c_f32_bf16 v129, v95, v138
    s_waitcnt lgkmcnt(0)
    v_mfma_f32_32x32x16_bf16 v[16:31], v[112:115], v[96:99], v[16:31]
    v_mfma_f32_32x32x16_bf16 v[16:31], v[116:119], v[100:103], v[16:31]
    v_mfma_f32_32x32x16_bf16 v[16:31], v[120:123], v[104:107], v[16:31]
    v_mfma_f32_32x32x16_bf16 v[16:31], v[124:127], v[108:111], v[16:31]
    v_mov_b32 v2, 516
    v_mov_b32 v3, 1
    s_mov_b64 exec, 1
    ds_add_u32 v2, v3
    s_mov_b64 exec, -1
    v_dot2c_f32_bf16 v128, v112, v138
    v_dot2c_f32_bf16 v129, v113, v138
    v_dot2c_f32_bf16 v128, v114, v138
    v_dot2c_f32_bf16 v129, v115, v138
    v_dot2c_f32_bf16 v128, v116, v138
    v_dot2c_f32_bf16 v129, v117, v138
    v_dot2c_f32_bf16 v128, v118, v138
    v_dot2c_f32_bf16 v129, v119, v138
    v_dot2c_f32_bf16 v128, v120, v138
    v_dot2c_f32_bf16 v129, v121, v138
    v_dot2c_f32_bf16 v128, v122, v138
    v_dot2c_f32_bf16 v129, v123, v138
    v_dot2c_f32_bf16 v128, v124, v138
    v_dot2c_f32_bf16 v129, v125, v138
    v_dot2c_f32_bf16 v128, v126, v138
    v_dot2c_f32_bf16 v129, v127, v138
    s_nop 2
    v_add_f32 v128, v128, v129
    v_mov_b32 v129, v128
    s_nop 1
    v_permlane32_swap_b32 v128, v129
    v_add_f32 v128, v128, v129
    s_lshl_b32 s13, s3, 8
    s_add_u32 s13, s13, 1024
    v_lshlrev_b32 v6, 2, v0
    v_add_u32 v6, s13, v6
    ds_write_b32 v6, v128
    v_lshrrev_b32 v7, 5, v0
    v_lshlrev_b32 v7, 4, v7
    v_add_u32 v7, s13, v7
    s_waitcnt lgkmcnt(0)
    ds_read_b128 v[64:67], v7 offset:0
    ds_read_b128 v[68:71], v7 offset:32
    ds_read_b128 v[72:75], v7 offset:64
    ds_read_b128 v[76:79], v7 offset:96
    s_lshl_b32 s13, s80, 12
    s_lshl_b32 s14, s81, 11
    s_add_u32 s13, s13, s14
    s_add_u32 s13, s13, 4096
    v_lshlrev_b32 v14, 4, v0
    v_add_u32 v14, s13, v14
    s_waitcnt lgkmcnt(0)
    v_pk_mul_f32 v[64:65], v[64:65], v[150:151] op_sel_hi:[1,0]
    v_pk_mul_f32 v[66:67], v[66:67], v[150:151] op_sel_hi:[1,0]
    v_pk_mul_f32 v[68:69], v[68:69], v[150:151] op_sel_hi:[1,0]
    v_pk_mul_f32 v[70:71], v[70:71], v[150:151] op_sel_hi:[1,0]
    v_pk_mul_f32 v[72:73], v[72:73], v[150:151] op_sel_hi:[1,0]
    v_pk_mul_f32 v[74:75], v[74:75], v[150:151] op_sel_hi:[1,0]
    v_pk_mul_f32 v[76:77], v[76:77], v[150:151] op_sel_hi:[1,0]
    v_pk_mul_f32 v[78:79], v[78:79], v[150:151] op_sel_hi:[1,0]
    v_pk_fma_f32 v[64:65], v[16:17], v[148:149], v[64:65] op_sel_hi:[1,0,1] neg_lo:[0,0,1] neg_hi:[0,0,1]
    v_pk_fma_f32 v[66:67], v[18:19], v[148:149], v[66:67] op_sel_hi:[1,0,1] neg_lo:[0,0,1] neg_hi:[0,0,1]
    v_pk_fma_f32 v[68:69], v[20:21], v[148:149], v[68:69] op_sel_hi:[1,0,1] neg_lo:[0,0,1] neg_hi:[0,0,1]
    v_pk_fma_f32 v[70:71], v[22:23], v[148:149], v[70:71] op_sel_hi:[1,0,1] neg_lo:[0,0,1] neg_hi:[0,0,1]
    v_pk_fma_f32 v[72:73], v[24:25], v[148:149], v[72:73] op_sel_hi:[1,0,1] neg_lo:[0,0,1] neg_hi:[0,0,1]
    v_pk_fma_f32 v[74:75], v[26:27], v[148:149], v[74:75] op_sel_hi:[1,0,1] neg_lo:[0,0,1] neg_hi:[0,0,1]
    v_pk_fma_f32 v[76:77], v[28:29], v[148:149], v[76:77] op_sel_hi:[1,0,1] neg_lo:[0,0,1] neg_hi:[0,0,1]
    v_pk_fma_f32 v[78:79], v[30:31], v[148:149], v[78:79] op_sel_hi:[1,0,1] neg_lo:[0,0,1] neg_hi:[0,0,1]
    v_cvt_pk_bf16_f32 v156, v64, v65
    v_cvt_pk_bf16_f32 v157, v66, v67
    v_cvt_pk_bf16_f32 v158, v68, v69
    v_cvt_pk_bf16_f32 v159, v70, v71
    v_cvt_pk_bf16_f32 v160, v72, v73
    v_cvt_pk_bf16_f32 v161, v74, v75
    v_cvt_pk_bf16_f32 v162, v76, v77
    v_cvt_pk_bf16_f32 v163, v78, v79
    ds_write_b128 v14, v[156:159]
    ds_write_b128 v14, v[160:163] offset:1024
    v_and_b32 v232, 31, v0
    v_lshrrev_b32 v233, 5, v0
    v_lshlrev_b32 v233, 2, v233
    v_sub_u32 v232, v232, v233
    v_mov_b32 v234, 0xff800000
    v_mov_b32 v235, 0
    v_cmp_le_i32 vcc, 0, v232
    s_nop 1
    v_cndmask_b32 v56, v234, v235, vcc
    v_cndmask_b32 v72, v235, v234, vcc
    v_cmp_le_i32 vcc, 1, v232
    s_nop 1
    v_cndmask_b32 v57, v234, v235, vcc
    v_cndmask_b32 v73, v235, v234, vcc
    v_cmp_le_i32 vcc, 2, v232
    s_nop 1
    v_cndmask_b32 v58, v234, v235, vcc
    v_cndmask_b32 v74, v235, v234, vcc
    v_cmp_le_i32 vcc, 3, v232
    s_nop 1
    v_cndmask_b32 v59, v234, v235, vcc
    v_cndmask_b32 v75, v235, v234, vcc
    v_cmp_le_i32 vcc, 8, v232
    s_nop 1
    v_cndmask_b32 v60, v234, v235, vcc
    v_cndmask_b32 v76, v235, v234, vcc
    v_cmp_le_i32 vcc, 9, v232
    s_nop 1
    v_cndmask_b32 v61, v234, v235, vcc
    v_cndmask_b32 v77, v235, v234, vcc
    v_cmp_le_i32 vcc, 10, v232
    s_nop 1
    v_cndmask_b32 v62, v234, v235, vcc
    v_cndmask_b32 v78, v235, v234, vcc
    v_cmp_le_i32 vcc, 11, v232
    s_nop 1
    v_cndmask_b32 v63, v234, v235, vcc
    v_cndmask_b32 v79, v235, v234, vcc
    v_cmp_le_i32 vcc, 16, v232
    s_nop 1
    v_cndmask_b32 v64, v234, v235, vcc
    v_cndmask_b32 v80, v235, v234, vcc
    v_cmp_le_i32 vcc, 17, v232
    s_nop 1
    v_cndmask_b32 v65, v234, v235, vcc
    v_cndmask_b32 v81, v235, v234, vcc
    v_cmp_le_i32 vcc, 18, v232
    s_nop 1
    v_cndmask_b32 v66, v234, v235, vcc
    v_cndmask_b32 v82, v235, v234, vcc
    v_cmp_le_i32 vcc, 19, v232
    s_nop 1
    v_cndmask_b32 v67, v234, v235, vcc
    v_cndmask_b32 v83, v235, v234, vcc
    v_cmp_le_i32 vcc, 24, v232
    s_nop 1
    v_cndmask_b32 v68, v234, v235, vcc
    v_cndmask_b32 v84, v235, v234, vcc
    v_cmp_le_i32 vcc, 25, v232
    s_nop 1
    v_cndmask_b32 v69, v234, v235, vcc
    v_cndmask_b32 v85, v235, v234, vcc
    v_cmp_le_i32 vcc, 26, v232
    s_nop 1
    v_cndmask_b32 v70, v234, v235, vcc
    v_cndmask_b32 v86, v235, v234, vcc
    v_cmp_le_i32 vcc, 27, v232
    s_nop 1
    v_cndmask_b32 v71, v234, v235, vcc
    v_cndmask_b32 v87, v235, v234, vcc
    v_lshrrev_b32 v2, 3, v0
    v_and_b32 v3, 7, v0
    v_bfe_u32 v4, v0, 4, 1
    v_lshlrev_b32 v4, 2, v4
    v_xor_b32 v4, v4, v3
    v_lshlrev_b32 v4, 4, v4
    v_lshl_add_u32 v243, v2, 10, v4
    s_lshl_b32 s23, s4, 1
    s_add_u32 s23, s23, s80
    v_and_b32 v4, 31, v0
    v_lshlrev_b32 v4, 10, v4
    v_lshrrev_b32 v5, 5, v0
    v_lshl_add_u32 v4, v5, 3, v4
    s_lshl_b32 s24, s23, 15
    s_lshl_b32 s13, s5, 7
    s_add_u32 s24, s24, s13
    s_lshl_b32 s13, s81, 6
    s_add_u32 s24, s24, s13
    v_mov_b32 v244, v4
    s_lshr_b32 s13, s3, 2
    s_lshl_b32 s21, s4, 1
    s_add_u32 s21, s21, s13
    s_sub_u32 s20, 8, s21
    s_max_i32 s20, s20, 0
    s_lshl_b32 s9, s13, 12
    s_lshl_b32 s12, s82, 10
    s_add_u32 s12, s12, s9
    s_add_u32 s12, s12, 12288
    v_lshlrev_b32 v232, 4, v0
    v_add_u32 v233, s12, v232
    s_lshl_b32 s12, s3, 10
    s_add_u32 s12, s12, 4096
    v_add_u32 v235, s12, v232
    s_mul_i32 s9, s13, 4224
    s_mul_i32 s12, s81, 2112
    s_add_u32 s12, s12, s9
    s_add_u32 s12, s12, 53248
    s_lshl_b32 s14, s80, 8
    v_or_b32 v236, s14, v232
    v_and_b32 v238, 11, v0
    v_cmp_eq_u32 vcc, 0, v238
    v_mov_b32 v237, 1040
    v_mov_b32 v238, 1024
    v_cndmask_b32 v237, v237, v238, vcc
    v_and_b32 v238, 16, v0
    v_cmp_eq_u32 vcc, 0, v238
    s_nop 1
    v_cndmask_b32 v236, v237, v236, vcc
    v_add_u32 v236, s12, v236
    s_lshl_b32 s22, s21, 5
    s_lshl_b32 s13, s5, 2
    s_add_u32 s22, s22, s13
    s_add_u32 s22, s22, s82
    s_lshl_b32 s27, s82, 17
    s_lshl_b32 s13, s5, 7
    s_add_u32 s27, s27, s13
    s_lshl_b32 s28, s82, 14
    s_add_u32 s28, s28, 98304
    v_add_u32 v2, 0, v0
    v_mul_u32_u24 v3, 171, v2
    v_lshrrev_b32 v3, 11, v3
    v_mul_u32_u24 v4, 12, v3
    v_sub_u32 v4, v2, v4
    v_mul_u32_u24 v3, 2752, v3
    v_lshl_add_u32 v8, v4, 4, v3
    v_add_u32 v2, 64, v0
    v_mul_u32_u24 v3, 171, v2
    v_lshrrev_b32 v3, 11, v3
    v_mul_u32_u24 v4, 12, v3
    v_sub_u32 v4, v2, v4
    v_mul_u32_u24 v3, 2752, v3
    v_lshl_add_u32 v9, v4, 4, v3
    v_add_u32 v2, 128, v0
    v_mul_u32_u24 v3, 171, v2
    v_lshrrev_b32 v3, 11, v3
    v_mul_u32_u24 v4, 12, v3
    v_sub_u32 v4, v2, v4
    v_mul_u32_u24 v3, 2752, v3
    v_lshl_add_u32 v10, v4, 4, v3
    v_lshlrev_b32 v245, 7, v0
    s_mov_b32 s19, 0
    s_mov_b32 s29, 0
    s_mov_b32 s30, 0
    v_lshlrev_b32 v14, 4, v0
    v_mov_b32 v210, 0
    s_waitcnt lgkmcnt(0)
    s_branch Latt
Lcompute:
    s_waitcnt lgkmcnt(0)
    s_mov_b32 s40, s16
    s_and_b32 s41, s17, 0xffff
    s_mov_b32 s42, 2097152
    s_mov_b32 s43, 0x20000
    s_mov_b32 s44, s18
    s_and_b32 s45, s19, 0xffff
    s_mov_b32 s46, 1572864
    s_mov_b32 s47, 0x20000
    s_lshr_b32 s6, s4, 1
    s_and_b32 s80, s3, 1
    s_bfe_u32 s81, s3, 0x10001
    s_mov_b32 s83, 0
    s_mov_b32 s72, s36
    s_and_b32 s73, s37, 0xffff
    s_mov_b32 s74, 268435456
    s_mov_b32 s75, 0x20000
    s_mov_b32 s76, s34
    s_and_b32 s77, s35, 0xffff
    s_mov_b32 s78, 256
    s_mov_b32 s79, 0x20000
    s_mov_b32 s48, s20
    s_and_b32 s49, s21, 0xffff
    s_mov_b32 s50, 524288
    s_mov_b32 s51, 0x20000
    s_mov_b32 s52, s24
    s_and_b32 s53, s25, 0xffff
    s_mov_b32 s54, 1409024
    s_mov_b32 s55, 0x20000
    s_mov_b32 s56, s26
    s_and_b32 s57, s27, 0xffff
    s_mov_b32 s58, 2752
    s_mov_b32 s59, 0x20000
    s_mov_b32 s60, s28
    s_and_b32 s61, s29, 0xffff
    s_mov_b32 s62, 1409024
    s_mov_b32 s63, 0x20000
    s_mov_b32 s64, s30
    s_and_b32 s65, s31, 0xffff
    s_mov_b32 s66, 1024
    s_mov_b32 s67, 0x20000
    s_mov_b32 s68, s32
    s_and_b32 s69, s33, 0xffff
    s_mov_b32 s70, 2097152
    s_mov_b32 s71, 0x20000
    s_getreg_b32 s39, hwreg(HW_REG_XCC_ID)
    s_and_b32 s39, s39, 15
    s_or_b32 s39, s39, 0x80
    s_cmp_lg_u32 s3, 0
    s_cbranch_scc1 L5
    s_lshl_b32 s8, s4, 5
    s_lshl_b32 s9, s5, 2
    s_add_u32 s8, s8, s9
    v_mov_b32 v2, 4080
    v_mov_b32 v3, 3060
    v_cmp_gt_u32 vcc, 16, v0
    s_nop 1
    v_cndmask_b32 v2, v2, v3, vcc
    s_add_u32 s9, s8, 1020
    v_mov_b32 v3, s9
    v_cmp_gt_u32 vcc, 12, v0
    s_nop 1
    v_cndmask_b32 v2, v2, v3, vcc
    v_mov_b32 v3, 0
    v_cmp_gt_u32 vcc, 4, v0
    s_nop 1
    v_cndmask_b32 v2, v2, v3, vcc
    v_add3_u32 v2, v2, v0, s8
    v_lshlrev_b32 v2, 7, v2
    v_add_u32 v2, 16777216, v2
    v_mov_b32 v3, 0
    s_mov_b32 exec_lo, 0xfffff
    s_mov_b32 exec_hi, 0
    buffer_store_dword v3, v2, s[72:75], 0 offen sc1
    v_lshlrev_b32 v4, 2, v0
    ds_write_b32 v4, v3 offset:512
    s_lshl_b32 s8, s6, 4
    s_and_b32 s9, s7, 12
    s_add_u32 s8, s8, s9
    s_and_b32 s9, s7, 3
    s_lshl_b32 s9, s9, 3
    s_lshl_b32 s9, s39, s9
    v_mov_b32 v2, s8
    v_mov_b32 v3, s9
    s_mov_b64 exec, 1
    s_waitcnt vmcnt(0)
    buffer_atomic_or v3, v2, s[76:79], 0 offen sc1
    s_mov_b64 exec, -1
    s_branch L6
L5:
    s_cmp_lg_u32 s3, 3
    s_cbranch_scc1 L6
    s_lshl_b32 s9, s4, 16
    s_load_dword s90, s[32:33], s9
    s_load_dword s90, s[20:21], 0
    s_load_dword s90, s[24:25], 0
    s_load_dword s90, s[26:27], 0
    s_load_dword s90, s[28:29], 0
    s_load_dword s90, s[30:31], 0
    s_mov_b32 s9, 1048576
    s_load_dword s90, s[36:37], s9
    s_mov_b32 s9, 3145728
    s_load_dword s90, s[36:37], s9
    s_mov_b32 s9, 5242880
    s_load_dword s90, s[36:37], s9
    s_mov_b32 s9, 7340032
    s_load_dword s90, s[36:37], s9
    s_mov_b32 s9, 9437184
    s_load_dword s90, s[36:37], s9
    s_mov_b32 s9, 11534336
    s_load_dword s90, s[36:37], s9
    s_mov_b32 s9, 13631488
    s_load_dword s90, s[36:37], s9
    s_mov_b32 s9, 15728640
    s_load_dword s90, s[36:37], s9
L6:
    v_mov_b32 v16, 0
    v_mov_b32 v17, 0
    v_mov_b32 v18, 0
    v_mov_b32 v19, 0
    v_mov_b32 v20, 0
    v_mov_b32 v21, 0
    v_mov_b32 v22, 0
    v_mov_b32 v23, 0
    v_mov_b32 v24, 0
    v_mov_b32 v25, 0
    v_mov_b32 v26, 0
    v_mov_b32 v27, 0
    v_mov_b32 v28, 0
    v_mov_b32 v29, 0
    v_mov_b32 v30, 0
    v_mov_b32 v31, 0
    v_mov_b32 v32, 0
    v_mov_b32 v33, 0
    v_mov_b32 v34, 0
    v_mov_b32 v35, 0
    v_mov_b32 v36, 0
    v_mov_b32 v37, 0
    v_mov_b32 v38, 0
    v_mov_b32 v39, 0
    v_mov_b32 v40, 0
    v_mov_b32 v41, 0
    v_mov_b32 v42, 0
    v_mov_b32 v43, 0
    v_mov_b32 v44, 0
    v_mov_b32 v45, 0
    v_mov_b32 v46, 0
    v_mov_b32 v47, 0
    v_mov_b32 v96, 0
    v_mov_b32 v97, 0
    v_mov_b32 v98, 0
    v_mov_b32 v99, 0
    v_mov_b32 v100, 0
    v_mov_b32 v101, 0
    v_mov_b32 v102, 0
    v_mov_b32 v103, 0
    v_mov_b32 v104, 0
    v_mov_b32 v105, 0
    v_mov_b32 v106, 0
    v_mov_b32 v107, 0
    v_mov_b32 v108, 0
    v_mov_b32 v109, 0
    v_mov_b32 v110, 0
    v_mov_b32 v111, 0
    v_mov_b32 v128, 0
    v_mov_b32 v129, 0
    v_mov_b32 v130, 0
    v_mov_b32 v131, 0
    v_mov_b32 v138, 0x3f803f80
    s_lshl_b32 s12, s80, 2
    v_and_b32 v2, 31, v0
    v_bfe_u32 v3, v0, 1, 3
    v_lshrrev_b32 v4, 5, v0
    v_xor_b32 v3, v3, v4
    s_lshl_b32 s13, s80, 12
    s_add_u32 s13, s13, 98304
    v_lshlrev_b32 v2, 7, v2
    v_add_u32 v2, s13, v2
    v_xor_b32 v3, s12, v3
    v_xor_b32 v4, 0, v3
    v_lshl_add_u32 v140, v4, 4, v2
    v_xor_b32 v4, 2, v3
    v_lshl_add_u32 v141, v4, 4, v2
    v_xor_b32 v4, 4, v3
    v_lshl_add_u32 v142, v4, 4, v2
    v_xor_b32 v4, 6, v3
    v_lshl_add_u32 v143, v4, 4, v2
    v_lshrrev_b32 v144, 5, v0
    v_mul_u32_u24 v144, 8, v144
    v_bfe_u32 v2, v0, 2, 2
    v_add_u32 v144, v144, v2
    v_mul_u32_u24 v144, 128, v144
    v_bfe_u32 v2, v0, 3, 1
    v_xor_b32 v2, s81, v2
    v_lshl_add_u32 v144, v2, 6, v144
    v_bfe_u32 v2, v0, 4, 1
    v_lshl_add_u32 v144, v2, 5, v144
    v_and_b32 v2, 3, v0
    v_lshl_add_u32 v144, v2, 3, v144
    s_lshl_b32 s13, s80, 12
    s_add_u32 s14, s13, 65536
    s_xor_b32 s13, s13, 4096
    s_add_u32 s13, s13, 65536
    v_add_u32 v145, s13, v144
    v_add_u32 v144, s14, v144
    s_mov_b32 s15, 0
    v_lshlrev_b32 v146, 2, v0
    s_cmp_lg_u32 s3, 1
    s_cbranch_scc1 L7
    s_mul_i32 s13, s2, 5504
    v_lshlrev_b32 v245, 7, v0
    s_mov_b32 exec_lo, 0xffffffff
    s_mov_b32 exec_hi, 0x7ff
    buffer_load_dword v239, v245, s[52:55], s13 offen
    s_mov_b64 exec, -1
L7:
    s_cmp_lg_u32 s3, 2
    s_cbranch_scc1 L8
    s_mul_i32 s13, s2, 5504
    v_lshlrev_b32 v245, 7, v0
    s_mov_b32 exec_lo, 0xffffffff
    s_mov_b32 exec_hi, 0x7ff
    buffer_load_dword v239, v245, s[60:63], s13 offen
    s_mov_b64 exec, -1
L8:
    s_cmp_lg_u32 s3, 3
    s_cbranch_scc1 L9
    s_mul_i32 s13, s2, 2048
    v_lshlrev_b32 v245, 7, v0
    s_mov_b32 exec_lo, 0xffff
    s_mov_b32 exec_hi, 0x0
    buffer_load_dword v239, v245, s[48:51], s13 offen
    s_mov_b64 exec, -1
L9:
    s_lshl_b32 s13, s3, 8
    s_add_u32 s13, s13, 1024
    v_add_u32 v6, s13, v146
    s_lshl_b32 s13, s81, 9
    s_add_u32 s13, s13, 1024
    v_lshrrev_b32 v7, 5, v0
    v_lshlrev_b32 v7, 4, v7
    v_add_u32 v8, s13, v7
    v_and_b32 v9, 31, v0
    v_lshlrev_b32 v9, 2, v9
    v_add_u32 v10, s13, v9
    s_lshl_b32 s13, s80, 7
    v_add_u32 v7, s13, v7
    v_add_u32 v9, s13, v9
    s_lshl_b32 s13, s4, 1
    s_add_u32 s13, s13, s80
    s_lshl_b32 s16, s13, 3
    s_add_u32 s16, s16, s5
    s_lshl_b32 s16, s16, 13
    s_lshl_b32 s14, s81, 11
    s_add_u32 s16, s16, s14
    s_add_u32 s17, s16, 4096
    s_lshl_b32 s18, s13, 4
    s_lshl_b32 s14, s5, 1
    s_add_u32 s18, s18, s14
    s_add_u32 s18, s18, s81
    v_lshlrev_b32 v14, 4, v0
Ls1:
    s_barrier
    ds_read_b128 v[64:67], v140
    ds_read_b64_tr_b16 v[80:81], v144 offset:0
    ds_read_b64_tr_b16 v[82:83], v144 offset:512
    ds_read_b64_tr_b16 v[84:85], v144 offset:8192
    ds_read_b64_tr_b16 v[86:87], v144 offset:8704
    ds_read_b128 v[68:71], v141
    ds_read_b64_tr_b16 v[88:89], v144 offset:2048
    ds_read_b64_tr_b16 v[90:91], v144 offset:2560
    ds_read_b64_tr_b16 v[92:93], v144 offset:10240
    ds_read_b64_tr_b16 v[94:95], v144 offset:10752
    s_cmp_lg_u32 s15, 4
    s_cbranch_scc1 L10
    buffer_load_dword v147, v146, s[76:79], 0 offen sc1
L10:
    s_cmp_lg_u32 s15, 7
    s_cbranch_scc1 L11
    s_mov_b32 s8, 0
L12:
    s_waitcnt vmcnt(0)
    v_and_b32 v2, 0x80808080, v147
    v_cmp_ne_u32 vcc, 0x80808080, v2
    s_add_u32 s8, s8, 1
    s_cbranch_vccz L13
    s_cmp_gt_u32 s8, 400000
    s_cbranch_scc1 L13
    buffer_load_dword v147, v146, s[76:79], 0 offen sc1
    s_branch L12
L13:
    s_mul_i32 s9, s39, 0x01010101
    v_cmp_eq_u32 vcc, s9, v147
    s_lshl_b32 s9, s6, 2
    s_lshr_b64 s[10:11], vcc, s9
    s_and_b32 s10, s10, 15
    s_cmp_eq_u32 s10, 15
    s_cselect_b32 s83, 1, 0
    v_mov_b32 v2, 520
    v_mov_b32 v3, s83
    ds_write_b32 v2, v3
L11:
    v_dot2c_f32_bf16 v128, v96, v138
    v_dot2c_f32_bf16 v130, v100, v138
    v_dot2c_f32_bf16 v129, v97, v138
    v_dot2c_f32_bf16 v131, v101, v138
    v_dot2c_f32_bf16 v128, v98, v138
    v_dot2c_f32_bf16 v130, v102, v138
    v_dot2c_f32_bf16 v129, v99, v138
    v_dot2c_f32_bf16 v131, v103, v138
    v_dot2c_f32_bf16 v128, v104, v138
    v_dot2c_f32_bf16 v130, v108, v138
    v_dot2c_f32_bf16 v129, v105, v138
    v_dot2c_f32_bf16 v131, v109, v138
    v_dot2c_f32_bf16 v128, v106, v138
    v_dot2c_f32_bf16 v130, v110, v138
    v_dot2c_f32_bf16 v129, v107, v138
    v_dot2c_f32_bf16 v131, v111, v138
    s_waitcnt lgkmcnt(0)
    v_mfma_f32_32x32x16_bf16 v[16:31], v[80:83], v[64:67], v[16:31]
    ds_read_b128 v[72:75], v142
    ds_read_b64_tr_b16 v[96:97], v145 offset:0
    ds_read_b64_tr_b16 v[98:99], v145 offset:512
    v_mfma_f32_32x32x16_bf16 v[32:47], v[64:67], v[84:87], v[32:47]
    ds_read_b64_tr_b16 v[100:101], v145 offset:8192
    ds_read_b64_tr_b16 v[102:103], v145 offset:8704
    ds_read_b128 v[76:79], v143
    v_mfma_f32_32x32x16_bf16 v[16:31], v[88:91], v[68:71], v[16:31]
    ds_read_b64_tr_b16 v[104:105], v145 offset:2048
    ds_read_b64_tr_b16 v[106:107], v145 offset:2560
    v_mfma_f32_32x32x16_bf16 v[32:47], v[68:71], v[92:95], v[32:47]
    ds_read_b64_tr_b16 v[108:109], v145 offset:10240
    ds_read_b64_tr_b16 v[110:111], v145 offset:10752
    s_mov_b32 s13, 16384
    s_cmp_eq_u32 s15, 1
    s_cselect_b32 s13, -65536, s13
    s_cmp_eq_u32 s15, 6
    s_cselect_b32 s13, -65536, s13
    s_add_u32 s15, s15, 1
    s_waitcnt lgkmcnt(5)
    v_mfma_f32_32x32x16_bf16 v[16:31], v[96:99], v[72:75], v[16:31]
    v_add_u32 v140, 8192, v140
    v_add_u32 v141, 8192, v141
    v_add_u32 v142, 8192, v142
    v_mfma_f32_32x32x16_bf16 v[32:47], v[72:75], v[100:103], v[32:47]
    v_add_u32 v143, 8192, v143
    v_add_u32 v144, s13, v144
    v_add_u32 v145, s13, v145
    s_waitcnt lgkmcnt(0)
    v_mfma_f32_32x32x16_bf16 v[16:31], v[104:107], v[76:79], v[16:31]
    v_mfma_f32_32x32x16_bf16 v[32:47], v[76:79], v[108:111], v[32:47]
    s_cmp_lt_u32 s15, 8
    s_cbranch_scc1 Ls1
    v_dot2c_f32_bf16 v128, v96, v138
    v_dot2c_f32_bf16 v130, v100, v138
    v_dot2c_f32_bf16 v129, v97, v138
    v_dot2c_f32_bf16 v131, v101, v138
    v_dot2c_f32_bf16 v128, v98, v138
    v_dot2c_f32_bf16 v130, v102, v138
    v_dot2c_f32_bf16 v129, v99, v138
    v_dot2c_f32_bf16 v131, v103, v138
    v_dot2c_f32_bf16 v128, v104, v138
    v_dot2c_f32_bf16 v130, v108, v138
    v_dot2c_f32_bf16 v129, v105, v138
    v_dot2c_f32_bf16 v131, v109, v138
    v_dot2c_f32_bf16 v128, v106, v138
    v_dot2c_f32_bf16 v130, v110, v138
    v_dot2c_f32_bf16 v129, v107, v138
    v_dot2c_f32_bf16 v131, v111, v138
    s_nop 1
    v_add_f32 v128, v128, v129
    v_add_f32 v130, v130, v131
    s_nop 1
    v_permlane32_swap_b32 v128, v130
    v_add_f32 v128, v128, v130
    ds_write_b32 v6, v128
    s_waitcnt lgkmcnt(0)
    s_barrier
    ds_read_b32 v148, v9 offset:0
    ds_read_b32 v150, v9 offset:256
    ds_read_b128 v[64:67], v8 offset:0
    ds_read_b128 v[68:71], v8 offset:32
    ds_read_b128 v[72:75], v8 offset:64
    ds_read_b128 v[76:79], v8 offset:96
    ds_read_b128 v[112:115], v8 offset:256
    ds_read_b128 v[116:119], v8 offset:288
    ds_read_b128 v[120:123], v8 offset:320
    ds_read_b128 v[124:127], v8 offset:352
    ds_read_b32 v152, v10 offset:128
    ds_read_b32 v153, v10 offset:384
    s_waitcnt lgkmcnt(2)
    ds_read_b128 v[96:99], v7 offset:256
    ds_read_b128 v[100:103], v7 offset:288
    ds_read_b128 v[104:107], v7 offset:320
    ds_read_b128 v[108:111], v7 offset:352
    ds_read_b128 v[80:83], v7 offset:0
    ds_read_b128 v[84:87], v7 offset:32
    ds_read_b128 v[88:91], v7 offset:64
    ds_read_b128 v[92:95], v7 offset:96
    v_pk_add_f32 v[64:65], v[64:65], v[112:113]
    v_pk_add_f32 v[66:67], v[66:67], v[114:115]
    v_pk_add_f32 v[68:69], v[68:69], v[116:117]
    v_pk_add_f32 v[70:71], v[70:71], v[118:119]
    v_pk_add_f32 v[72:73], v[72:73], v[120:121]
    v_pk_add_f32 v[74:75], v[74:75], v[122:123]
    v_pk_add_f32 v[76:77], v[76:77], v[124:125]
    v_pk_add_f32 v[78:79], v[78:79], v[126:127]
    v_pk_mul_f32 v[64:65], v[64:65], v[150:151] op_sel_hi:[1,0]
    v_pk_mul_f32 v[66:67], v[66:67], v[150:151] op_sel_hi:[1,0]
    v_pk_mul_f32 v[68:69], v[68:69], v[150:151] op_sel_hi:[1,0]
    v_pk_mul_f32 v[70:71], v[70:71], v[150:151] op_sel_hi:[1,0]
    v_pk_mul_f32 v[72:73], v[72:73], v[150:151] op_sel_hi:[1,0]
    v_pk_mul_f32 v[74:75], v[74:75], v[150:151] op_sel_hi:[1,0]
    v_pk_mul_f32 v[76:77], v[76:77], v[150:151] op_sel_hi:[1,0]
    v_pk_mul_f32 v[78:79], v[78:79], v[150:151] op_sel_hi:[1,0]
    v_pk_fma_f32 v[64:65], v[16:17], v[148:149], v[64:65] op_sel_hi:[1,0,1] neg_lo:[0,0,1] neg_hi:[0,0,1]
    v_pk_fma_f32 v[66:67], v[18:19], v[148:149], v[66:67] op_sel_hi:[1,0,1] neg_lo:[0,0,1] neg_hi:[0,0,1]
    v_pk_fma_f32 v[68:69], v[20:21], v[148:149], v[68:69] op_sel_hi:[1,0,1] neg_lo:[0,0,1] neg_hi:[0,0,1]
    v_pk_fma_f32 v[70:71], v[22:23], v[148:149], v[70:71] op_sel_hi:[1,0,1] neg_lo:[0,0,1] neg_hi:[0,0,1]
    v_pk_fma_f32 v[72:73], v[24:25], v[148:149], v[72:73] op_sel_hi:[1,0,1] neg_lo:[0,0,1] neg_hi:[0,0,1]
    v_pk_fma_f32 v[74:75], v[26:27], v[148:149], v[74:75] op_sel_hi:[1,0,1] neg_lo:[0,0,1] neg_hi:[0,0,1]
    v_pk_fma_f32 v[76:77], v[28:29], v[148:149], v[76:77] op_sel_hi:[1,0,1] neg_lo:[0,0,1] neg_hi:[0,0,1]
    v_pk_fma_f32 v[78:79], v[30:31], v[148:149], v[78:79] op_sel_hi:[1,0,1] neg_lo:[0,0,1] neg_hi:[0,0,1]
    v_cvt_pk_bf16_f32 v156, v64, v65
    v_cvt_pk_bf16_f32 v157, v66, v67
    v_cvt_pk_bf16_f32 v158, v68, v69
    v_cvt_pk_bf16_f32 v159, v70, v71
    v_cvt_pk_bf16_f32 v160, v72, v73
    v_cvt_pk_bf16_f32 v161, v74, v75
    v_cvt_pk_bf16_f32 v162, v76, v77
    v_cvt_pk_bf16_f32 v163, v78, v79
    buffer_store_dwordx4 v[156:159], v14, s[72:75], s16 offen sc1
    buffer_store_dwordx4 v[160:163], v14, s[72:75], s16 offen offset:1024 sc1
    s_waitcnt lgkmcnt(0)
    v_add_f32 v152, v152, v153
    v_pk_mul_f32 v[96:97], v[96:97], v[152:153] op_sel_hi:[1,0]
    v_pk_mul_f32 v[98:99], v[98:99], v[152:153] op_sel_hi:[1,0]
    v_pk_mul_f32 v[100:101], v[100:101], v[152:153] op_sel_hi:[1,0]
    v_pk_mul_f32 v[102:103], v[102:103], v[152:153] op_sel_hi:[1,0]
    v_pk_mul_f32 v[104:105], v[104:105], v[152:153] op_sel_hi:[1,0]
    v_pk_mul_f32 v[106:107], v[106:107], v[152:153] op_sel_hi:[1,0]
    v_pk_mul_f32 v[108:109], v[108:109], v[152:153] op_sel_hi:[1,0]
    v_pk_mul_f32 v[110:111], v[110:111], v[152:153] op_sel_hi:[1,0]
    v_pk_fma_f32 v[96:97], v[32:33], v[80:81], v[96:97] neg_lo:[0,0,1] neg_hi:[0,0,1]
    v_pk_fma_f32 v[98:99], v[34:35], v[82:83], v[98:99] neg_lo:[0,0,1] neg_hi:[0,0,1]
    v_pk_fma_f32 v[100:101], v[36:37], v[84:85], v[100:101] neg_lo:[0,0,1] neg_hi:[0,0,1]
    v_pk_fma_f32 v[102:103], v[38:39], v[86:87], v[102:103] neg_lo:[0,0,1] neg_hi:[0,0,1]
    v_pk_fma_f32 v[104:105], v[40:41], v[88:89], v[104:105] neg_lo:[0,0,1] neg_hi:[0,0,1]
    v_pk_fma_f32 v[106:107], v[42:43], v[90:91], v[106:107] neg_lo:[0,0,1] neg_hi:[0,0,1]
    v_pk_fma_f32 v[108:109], v[44:45], v[92:93], v[108:109] neg_lo:[0,0,1] neg_hi:[0,0,1]
    v_pk_fma_f32 v[110:111], v[46:47], v[94:95], v[110:111] neg_lo:[0,0,1] neg_hi:[0,0,1]
    v_cvt_pk_bf16_f32 v164, v96, v97
    v_cvt_pk_bf16_f32 v165, v98, v99
    v_cvt_pk_bf16_f32 v166, v100, v101
    v_cvt_pk_bf16_f32 v167, v102, v103
    v_cvt_pk_bf16_f32 v168, v104, v105
    v_cvt_pk_bf16_f32 v169, v106, v107
    v_cvt_pk_bf16_f32 v170, v108, v109
    v_cvt_pk_bf16_f32 v171, v110, v111
    buffer_store_dwordx4 v[164:167], v14, s[72:75], s17 offen sc1
    buffer_store_dwordx4 v[168:171], v14, s[72:75], s17 offen offset:1024 sc1
    v_and_b32 v232, 31, v0
    v_lshrrev_b32 v233, 5, v0
    v_lshlrev_b32 v233, 2, v233
    v_sub_u32 v232, v232, v233
    v_mov_b32 v234, 0xff800000
    v_mov_b32 v235, 0
    v_cmp_le_i32 vcc, 0, v232
    s_nop 1
    v_cndmask_b32 v56, v234, v235, vcc
    v_cndmask_b32 v72, v235, v234, vcc
    v_cmp_le_i32 vcc, 1, v232
    s_nop 1
    v_cndmask_b32 v57, v234, v235, vcc
    v_cndmask_b32 v73, v235, v234, vcc
    v_cmp_le_i32 vcc, 2, v232
    s_nop 1
    v_cndmask_b32 v58, v234, v235, vcc
    v_cndmask_b32 v74, v235, v234, vcc
    v_cmp_le_i32 vcc, 3, v232
    s_nop 1
    v_cndmask_b32 v59, v234, v235, vcc
    v_cndmask_b32 v75, v235, v234, vcc
    v_cmp_le_i32 vcc, 8, v232
    s_nop 1
    v_cndmask_b32 v60, v234, v235, vcc
    v_cndmask_b32 v76, v235, v234, vcc
    v_cmp_le_i32 vcc, 9, v232
    s_nop 1
    v_cndmask_b32 v61, v234, v235, vcc
    v_cndmask_b32 v77, v235, v234, vcc
    v_cmp_le_i32 vcc, 10, v232
    s_nop 1
    v_cndmask_b32 v62, v234, v235, vcc
    v_cndmask_b32 v78, v235, v234, vcc
    v_cmp_le_i32 vcc, 11, v232
    s_nop 1
    v_cndmask_b32 v63, v234, v235, vcc
    v_cndmask_b32 v79, v235, v234, vcc
    v_cmp_le_i32 vcc, 16, v232
    s_nop 1
    v_cndmask_b32 v64, v234, v235, vcc
    v_cndmask_b32 v80, v235, v234, vcc
    v_cmp_le_i32 vcc, 17, v232
    s_nop 1
    v_cndmask_b32 v65, v234, v235, vcc
    v_cndmask_b32 v81, v235, v234, vcc
    v_cmp_le_i32 vcc, 18, v232
    s_nop 1
    v_cndmask_b32 v66, v234, v235, vcc
    v_cndmask_b32 v82, v235, v234, vcc
    v_cmp_le_i32 vcc, 19, v232
    s_nop 1
    v_cndmask_b32 v67, v234, v235, vcc
    v_cndmask_b32 v83, v235, v234, vcc
    v_cmp_le_i32 vcc, 24, v232
    s_nop 1
    v_cndmask_b32 v68, v234, v235, vcc
    v_cndmask_b32 v84, v235, v234, vcc
    v_cmp_le_i32 vcc, 25, v232
    s_nop 1
    v_cndmask_b32 v69, v234, v235, vcc
    v_cndmask_b32 v85, v235, v234, vcc
    v_cmp_le_i32 vcc, 26, v232
    s_nop 1
    v_cndmask_b32 v70, v234, v235, vcc
    v_cndmask_b32 v86, v235, v234, vcc
    v_cmp_le_i32 vcc, 27, v232
    s_nop 1
    v_cndmask_b32 v71, v234, v235, vcc
    v_cndmask_b32 v87, v235, v234, vcc
    v_lshrrev_b32 v2, 3, v0
    v_and_b32 v3, 7, v0
    v_bfe_u32 v4, v0, 4, 1
    v_lshlrev_b32 v4, 2, v4
    v_xor_b32 v4, v4, v3
    v_lshlrev_b32 v4, 4, v4
    v_lshl_add_u32 v243, v2, 10, v4
    s_lshl_b32 s23, s4, 1
    s_add_u32 s23, s23, s80
    v_and_b32 v4, 31, v0
    v_lshlrev_b32 v4, 10, v4
    v_lshrrev_b32 v5, 5, v0
    v_lshl_add_u32 v4, v5, 3, v4
    s_lshl_b32 s24, s23, 15
    s_lshl_b32 s13, s5, 7
    s_add_u32 s24, s24, s13
    s_lshl_b32 s13, s81, 6
    s_add_u32 s24, s24, s13
    v_mov_b32 v244, v4
    s_lshr_b32 s13, s3, 2
    s_lshl_b32 s21, s4, 1
    s_add_u32 s21, s21, s13
    s_sub_u32 s20, 8, s21
    s_max_i32 s20, s20, 0
    s_lshl_b32 s9, s13, 12
    s_lshl_b32 s12, s82, 10
    s_add_u32 s12, s12, s9
    s_add_u32 s12, s12, 12288
    v_lshlrev_b32 v232, 4, v0
    v_add_u32 v233, s12, v232
    s_lshl_b32 s12, s3, 10
    s_add_u32 s12, s12, 4096
    v_add_u32 v235, s12, v232
    s_mul_i32 s9, s13, 4224
    s_mul_i32 s12, s81, 2112
    s_add_u32 s12, s12, s9
    s_add_u32 s12, s12, 53248
    s_lshl_b32 s14, s80, 8
    v_or_b32 v236, s14, v232
    v_and_b32 v238, 11, v0
    v_cmp_eq_u32 vcc, 0, v238
    v_mov_b32 v237, 1040
    v_mov_b32 v238, 1024
    v_cndmask_b32 v237, v237, v238, vcc
    v_and_b32 v238, 16, v0
    v_cmp_eq_u32 vcc, 0, v238
    s_nop 1
    v_cndmask_b32 v236, v237, v236, vcc
    v_add_u32 v236, s12, v236
    s_lshl_b32 s22, s21, 5
    s_lshl_b32 s13, s5, 2
    s_add_u32 s22, s22, s13
    s_add_u32 s22, s22, s82
    s_lshl_b32 s27, s82, 17
    s_lshl_b32 s13, s5, 7
    s_add_u32 s27, s27, s13
    s_lshl_b32 s28, s82, 14
    s_add_u32 s28, s28, 98304
    v_add_u32 v2, 0, v0
    v_mul_u32_u24 v3, 171, v2
    v_lshrrev_b32 v3, 11, v3
    v_mul_u32_u24 v4, 12, v3
    v_sub_u32 v4, v2, v4
    v_mul_u32_u24 v3, 2752, v3
    v_lshl_add_u32 v8, v4, 4, v3
    v_add_u32 v2, 64, v0
    v_mul_u32_u24 v3, 171, v2
    v_lshrrev_b32 v3, 11, v3
    v_mul_u32_u24 v4, 12, v3
    v_sub_u32 v4, v2, v4
    v_mul_u32_u24 v3, 2752, v3
    v_lshl_add_u32 v9, v4, 4, v3
    v_add_u32 v2, 128, v0
    v_mul_u32_u24 v3, 171, v2
    v_lshrrev_b32 v3, 11, v3
    v_mul_u32_u24 v4, 12, v3
    v_sub_u32 v4, v2, v4
    v_mul_u32_u24 v3, 2752, v3
    v_lshl_add_u32 v10, v4, 4, v3
    v_lshlrev_b32 v245, 7, v0
    s_lshl_b32 s13, s80, 12
    s_lshl_b32 s14, s81, 11
    s_add_u32 s13, s13, s14
    s_add_u32 s13, s13, 45056
    v_add_u32 v15, s13, v14
    s_mul_i32 s13, s80, 4224
    s_mul_i32 s14, s81, 2112
    s_add_u32 s13, s13, s14
    s_add_u32 s13, s13, 87040
    v_add_u32 v146, s13, v14
    v_lshrrev_b32 v208, 2, v0
    v_mul_u32_u24 v208, 4224, v208
    v_and_b32 v209, 3, v0
    v_mul_u32_u24 v209, 1056, v209
    v_add_u32 v208, v208, v209
    v_mov_b32 v204, 0x3f803f80
    v_mov_b32 v212, 0
    v_mov_b32 v205, 0x3f803f80
    v_mov_b32 v213, 0
    v_mov_b32 v206, 0x3f803f80
    v_mov_b32 v214, 0
    v_mov_b32 v207, 0x3f803f80
    v_mov_b32 v215, 0
    s_waitcnt vmcnt(0)
    s_lshl_b32 s9, s18, 7
    s_add_u32 s9, s9, 16777216
    v_mov_b32 v2, s9
    v_mov_b32 v3, 1
    s_mov_b64 exec, 1
    buffer_store_dword v3, v2, s[72:75], 0 offen sc1
    s_mov_b64 exec, -1
    s_mov_b32 s16, 0
    v_mov_b32 v210, 0
    s_add_u32 s19, s4, s82
    s_cmp_lt_u32 s19, 4
    s_cbranch_scc1 L14
    s_sub_u32 s13, s19, 4
    s_lshl_b32 s13, s13, 1
    s_lshl_b32 s14, s13, 4
    s_lshl_b32 s15, s5, 1
    s_add_u32 s14, s14, s15
    v_lshrrev_b32 v2, 1, v0
    v_lshlrev_b32 v2, 4, v2
    v_and_b32 v3, 1, v0
    v_add3_u32 v2, v2, v3, s14
    v_lshlrev_b32 v2, 7, v2
    v_add_u32 v2, 16777216, v2
    s_lshl_b32 s16, s13, 3
    s_add_u32 s16, s16, s5
    s_lshl_b32 s16, s16, 13
    v_add_u32 v210, 655360, v2
    s_mov_b32 exec_lo, 0xf
    s_mov_b32 exec_hi, 0
    s_mov_b32 s8, 0
Lpoll16:
    buffer_load_dword v3, v2, s[72:75], 0 offen sc1
    s_add_u32 s8, s8, 1
    s_waitcnt vmcnt(0)
    v_cmp_eq_u32 vcc, 0, v3
    s_cmp_gt_u32 s8, 400000
    s_cbranch_scc1 Lpd17
    s_cbranch_vccnz Lpoll16
Lpd17:
    s_mov_b64 exec, -1
L14:
    v_mov_b32 v2, 516
    s_mov_b32 s8, 0
Llw18:
    ds_read_b32 v3, v2
    s_add_u32 s8, s8, 1
    s_waitcnt lgkmcnt(0)
    v_readfirstlane_b32 s9, v3
    s_cmp_gt_u32 s8, 1600000
    s_cbranch_scc1 Llwd19
    s_cmp_lt_u32 s9, 4
    s_cbranch_scc1 Llw18
Llwd19:
    s_cmp_lt_u32 s19, 4
    s_cbranch_scc1 L15
    s_lshl_b32 s17, s82, 13
    s_add_u32 s17, s17, 12288
    s_add_u32 s13, s16, 0
    s_add_u32 m0, s17, 0
    s_nop 0
    buffer_load_dwordx4 v14, s[72:75], s13 offen sc1 lds
    s_add_u32 s13, s16, 1024
    s_add_u32 m0, s17, 1024
    s_nop 0
    buffer_load_dwordx4 v14, s[72:75], s13 offen sc1 lds
    s_add_u32 s13, s16, 2048
    s_add_u32 m0, s17, 2048
    s_nop 0
    buffer_load_dwordx4 v14, s[72:75], s13 offen sc1 lds
    s_add_u32 s13, s16, 3072
    s_add_u32 m0, s17, 3072
    s_nop 0
    buffer_load_dwordx4 v14, s[72:75], s13 offen sc1 lds
    s_add_u32 s13, s16, 65536
    s_add_u32 m0, s17, 4096
    s_nop 0
    buffer_load_dwordx4 v14, s[72:75], s13 offen sc1 lds
    s_add_u32 s13, s16, 66560
    s_add_u32 m0, s17, 5120
    s_nop 0
    buffer_load_dwordx4 v14, s[72:75], s13 offen sc1 lds
    s_add_u32 s13, s16, 67584
    s_add_u32 m0, s17, 6144
    s_nop 0
    buffer_load_dwordx4 v14, s[72:75], s13 offen sc1 lds
    s_add_u32 s13, s16, 68608
    s_add_u32 m0, s17, 7168
    s_nop 0
    buffer_load_dwordx4 v14, s[72:75], s13 offen sc1 lds
L15:
    s_mov_b32 s29, s16
    s_mul_i32 s30, s82, 8448
    s_add_u32 s30, s30, 53248
    ds_write_b128 v15, v[156:159]
    ds_write_b128 v15, v[160:163] offset:1024
    ds_write_b128 v146, v[164:167]
    ds_write_b128 v146, v[168:171] offset:1056
    s_mov_b32 exec_hi, 0xff
    ds_write_b128 v208, v[204:207] offset:54272
    ds_write_b128 v208, v[212:215] offset:54288
    s_mov_b32 exec_hi, -1
    s_waitcnt lgkmcnt(0)
Latt:
    s_mov_b32 s31, 0
    s_barrier
    ds_read_b128 v[52:55], v235
    ds_read_b128 v[48:51], v233 offset:32768
    s_cmp_lt_u32 s3, 4
    s_cbranch_scc1 L20
    s_setprio 1
L20:
    s_cmp_lt_u32 s19, 4
    s_cbranch_scc1 L21
    s_add_u32 s13, s29, 4096
    s_add_u32 m0, s30, 0
    s_nop 0
    buffer_load_dwordx4 v14, s[72:75], s13 offen sc1 lds
    s_add_u32 s13, s29, 5120
    s_add_u32 m0, s30, 1056
    s_nop 0
    buffer_load_dwordx4 v14, s[72:75], s13 offen sc1 lds
    s_add_u32 s13, s29, 6144
    s_add_u32 m0, s30, 2112
    s_nop 0
    buffer_load_dwordx4 v14, s[72:75], s13 offen sc1 lds
    s_add_u32 s13, s29, 7168
    s_add_u32 m0, s30, 3168
    s_nop 0
    buffer_load_dwordx4 v14, s[72:75], s13 offen sc1 lds
    s_add_u32 s13, s29, 69632
    s_add_u32 m0, s30, 4224
    s_nop 0
    buffer_load_dwordx4 v14, s[72:75], s13 offen sc1 lds
    s_add_u32 s13, s29, 70656
    s_add_u32 m0, s30, 5280
    s_nop 0
    buffer_load_dwordx4 v14, s[72:75], s13 offen sc1 lds
    s_add_u32 s13, s29, 71680
    s_add_u32 m0, s30, 6336
    s_nop 0
    buffer_load_dwordx4 v14, s[72:75], s13 offen sc1 lds
    s_add_u32 s13, s29, 72704
    s_add_u32 m0, s30, 7392
    s_nop 0
    buffer_load_dwordx4 v14, s[72:75], s13 offen sc1 lds
L21:
    v_mov_b32 v238, 0xff800000
    v_mov_b32 v237, 0xff800000
    s_waitcnt lgkmcnt(0)
    v_mfma_f32_32x32x16_bf16 v[120:135], v[48:51], v[52:55], v[56:71]
    s_nop 11
    v_max3_f32 v238, v120, v121, v238
    v_max3_f32 v237, v122, v123, v237
    v_max3_f32 v238, v124, v125, v238
    v_max3_f32 v237, v126, v127, v237
    v_max3_f32 v238, v128, v129, v238
    v_max3_f32 v237, v130, v131, v237
    v_max3_f32 v238, v132, v133, v238
    v_max3_f32 v237, v134, v135, v237
    v_max_f32 v238, v238, v237
    v_mov_b32 v237, v238
    s_nop 1
    v_permlane32_swap_b32 v238, v237
    v_max_f32 v238, v238, v237
Lp2:
    ds_read_b128 v[200:203], v236 offset:33792
    ds_read_b128 v[204:207], v236 offset:34848
    v_sub_f32 v120, v120, v238
    v_sub_f32 v121, v121, v238
    v_sub_f32 v122, v122, v238
    v_sub_f32 v123, v123, v238
    v_sub_f32 v124, v124, v238
    v_sub_f32 v125, v125, v238
    v_sub_f32 v126, v126, v238
    v_sub_f32 v127, v127, v238
    v_sub_f32 v128, v128, v238
    v_sub_f32 v129, v129, v238
    v_sub_f32 v130, v130, v238
    v_sub_f32 v131, v131, v238
    v_sub_f32 v132, v132, v238
    v_sub_f32 v133, v133, v238
    v_sub_f32 v134, v134, v238
    v_sub_f32 v135, v135, v238
    v_exp_f32 v120, v120
    v_sub_f32 v136, 0, v238
    v_exp_f32 v121, v121
    v_sub_f32 v137, 0, v238
    v_exp_f32 v122, v122
    v_sub_f32 v138, 0, v238
    v_exp_f32 v123, v123
    v_sub_f32 v139, 0, v238
    v_exp_f32 v124, v124
    v_sub_f32 v140, 0, v238
    v_exp_f32 v125, v125
    v_sub_f32 v141, 0, v238
    v_exp_f32 v126, v126
    v_sub_f32 v142, 0, v238
    v_exp_f32 v127, v127
    v_sub_f32 v143, 0, v238
    v_exp_f32 v128, v128
    v_sub_f32 v144, 0, v238
    v_exp_f32 v129, v129
    v_sub_f32 v145, 0, v238
    v_exp_f32 v130, v130
    v_sub_f32 v146, 0, v238
    v_exp_f32 v131, v131
    v_sub_f32 v147, 0, v238
    v_exp_f32 v132, v132
    v_sub_f32 v148, 0, v238
    v_exp_f32 v133, v133
    v_sub_f32 v149, 0, v238
    v_exp_f32 v134, v134
    v_sub_f32 v150, 0, v238
    v_exp_f32 v135, v135
    v_sub_f32 v151, 0, v238
    v_cvt_pk_bf16_f32 v168, v120, v121
    v_cvt_pk_bf16_f32 v169, v122, v123
    v_cvt_pk_bf16_f32 v170, v124, v125
    v_cvt_pk_bf16_f32 v171, v126, v127
    v_cvt_pk_bf16_f32 v172, v128, v129
    v_cvt_pk_bf16_f32 v173, v130, v131
    v_cvt_pk_bf16_f32 v174, v132, v133
    v_cvt_pk_bf16_f32 v175, v134, v135
    v_sub_f32 v72, v72, v238
    v_sub_f32 v73, v73, v238
    v_sub_f32 v74, v74, v238
    v_sub_f32 v75, v75, v238
    v_sub_f32 v76, v76, v238
    v_sub_f32 v77, v77, v238
    v_sub_f32 v78, v78, v238
    v_sub_f32 v79, v79, v238
    v_sub_f32 v80, v80, v238
    v_sub_f32 v81, v81, v238
    v_sub_f32 v82, v82, v238
    v_sub_f32 v83, v83, v238
    v_sub_f32 v84, v84, v238
    v_sub_f32 v85, v85, v238
    v_sub_f32 v86, v86, v238
    v_sub_f32 v87, v87, v238
    s_waitcnt lgkmcnt(0)
    s_cmp_lg_u32 s31, 0
    s_cbranch_scc1 L22
    s_cmp_ge_u32 s3, 4
    s_cbranch_scc1 L23
    s_waitcnt vmcnt(8)
    v_mov_b32 v2, 536
    v_mov_b32 v3, 1
    s_mov_b64 exec, 1
    ds_add_u32 v2, v3
    s_mov_b64 exec, -1
L23:
    v_mov_b32 v2, 536
    s_mov_b32 s8, 0
Llw24:
    ds_read_b32 v3, v2
    s_add_u32 s8, s8, 1
    s_waitcnt lgkmcnt(0)
    v_readfirstlane_b32 s9, v3
    s_cmp_gt_u32 s8, 1600000
    s_cbranch_scc1 Llwd25
    s_cmp_lt_u32 s9, 4
    s_cbranch_scc1 Llw24
Llwd25:
    ds_read_b128 v[44:47], v233 offset:28672
    ds_read_b128 v[40:43], v233 offset:24576
    ds_read_b128 v[36:39], v233 offset:20480
    ds_read_b128 v[32:35], v233 offset:16384
    ds_read_b128 v[28:31], v233 offset:12288
    ds_read_b128 v[24:27], v233 offset:8192
    ds_read_b128 v[20:23], v233 offset:4096
    ds_read_b128 v[16:19], v233 offset:0
L22:
    s_waitcnt lgkmcnt(6)
    v_mfma_f32_32x32x16_bf16 v[104:119], v[44:47], v[52:55], v[136:151]
    v_mfma_f32_32x32x16_bf16 v[88:103], v[40:43], v[52:55], v[136:151]
    s_cmp_gt_u32 s20, 7
    s_cbranch_scc1 L27
    s_nop 8
    v_exp_f32 v104, v104
    v_exp_f32 v105, v105
    v_exp_f32 v106, v106
    v_exp_f32 v107, v107
    v_mfma_f32_32x32x16_bf16 v[152:167], v[200:203], v[168:171], 0
    v_exp_f32 v108, v108
    v_exp_f32 v109, v109
    v_cvt_pk_bf16_f32 v176, v104, v105
    v_cvt_pk_bf16_f32 v177, v106, v107
    v_exp_f32 v110, v110
    v_exp_f32 v111, v111
    v_mfma_f32_32x32x16_bf16 v[152:167], v[204:207], v[172:175], v[152:167]
L27:
    s_waitcnt lgkmcnt(0)
    s_cmp_lg_u32 s31, 0
    s_cbranch_scc1 L30
    v_mov_b32 v2, 524
    v_mov_b32 v3, 1
    s_mov_b64 exec, 1
    ds_add_u32 v2, v3
    s_mov_b64 exec, -1
    s_cmp_ge_u32 s3, 4
    s_cbranch_scc1 L28
    s_waitcnt vmcnt(0)
    v_mov_b32 v2, 532
    v_mov_b32 v3, 1
    s_mov_b64 exec, 1
    ds_add_u32 v2, v3
    s_mov_b64 exec, -1
    buffer_load_dwordx2 v[248:249], v244, s[40:43], s24 offen offset:0
    buffer_load_dwordx2 v[250:251], v244, s[40:43], s24 offen offset:16
    buffer_load_dwordx2 v[252:253], v244, s[40:43], s24 offen offset:32
    buffer_load_dwordx2 v[254:255], v244, s[40:43], s24 offen offset:48
    s_add_u32 s13, s27, 0
    s_add_u32 m0, s28, 0
    s_nop 0
    buffer_load_dwordx4 v243, s[48:51], s13 offen lds
    s_add_u32 s13, s27, 8192
    s_add_u32 m0, s28, 1024
    s_nop 0
    buffer_load_dwordx4 v243, s[48:51], s13 offen lds
    s_add_u32 s13, s27, 16384
    s_add_u32 m0, s28, 2048
    s_nop 0
    buffer_load_dwordx4 v243, s[48:51], s13 offen lds
    s_add_u32 s13, s27, 24576
    s_add_u32 m0, s28, 3072
    s_nop 0
    buffer_load_dwordx4 v243, s[48:51], s13 offen lds
    s_add_u32 s13, s27, 32768
    s_add_u32 m0, s28, 4096
    s_nop 0
    buffer_load_dwordx4 v243, s[48:51], s13 offen lds
    s_add_u32 s13, s27, 40960
    s_add_u32 m0, s28, 5120
    s_nop 0
    buffer_load_dwordx4 v243, s[48:51], s13 offen lds
    s_add_u32 s13, s27, 49152
    s_add_u32 m0, s28, 6144
    s_nop 0
    buffer_load_dwordx4 v243, s[48:51], s13 offen lds
    s_add_u32 s13, s27, 57344
    s_add_u32 m0, s28, 7168
    s_nop 0
    buffer_load_dwordx4 v243, s[48:51], s13 offen lds
    s_add_u32 s13, s27, 65536
    s_add_u32 m0, s28, 8192
    s_nop 0
    buffer_load_dwordx4 v243, s[48:51], s13 offen lds
    s_add_u32 s13, s27, 73728
    s_add_u32 m0, s28, 9216
    s_nop 0
    buffer_load_dwordx4 v243, s[48:51], s13 offen lds
    s_add_u32 s13, s27, 81920
    s_add_u32 m0, s28, 10240
    s_nop 0
    buffer_load_dwordx4 v243, s[48:51], s13 offen lds
    s_add_u32 s13, s27, 90112
    s_add_u32 m0, s28, 11264
    s_nop 0
    buffer_load_dwordx4 v243, s[48:51], s13 offen lds
    s_add_u32 s13, s27, 98304
    s_add_u32 m0, s28, 12288
    s_nop 0
    buffer_load_dwordx4 v243, s[48:51], s13 offen lds
    s_add_u32 s13, s27, 106496
    s_add_u32 m0, s28, 13312
    s_nop 0
    buffer_load_dwordx4 v243, s[48:51], s13 offen lds
    s_add_u32 s13, s27, 114688
    s_add_u32 m0, s28, 14336
    s_nop 0
    buffer_load_dwordx4 v243, s[48:51], s13 offen lds
    s_add_u32 s13, s27, 122880
    s_add_u32 m0, s28, 15360
    s_nop 0
    buffer_load_dwordx4 v243, s[48:51], s13 offen lds
    s_cmp_lg_u32 s7, 15
    s_cbranch_scc1 L31
    s_mul_i32 s26, s80, 704512
    s_lshl_b32 s13, s81, 13
    s_add_u32 s26, s26, s13
    s_and_b32 s13, s6, 1
    s_lshl_b32 s13, s13, 14
    s_add_u32 s26, s26, s13
    s_add_u32 s26, s26, 245760
    s_mov_b32 s19, 3
    v_lshlrev_b32 v245, 7, v0
L32:
    buffer_load_dword v239, v245, s[60:63], s26 offen
    s_add_u32 s26, s26, 32768
    s_sub_u32 s19, s19, 1
    s_cmp_lg_u32 s19, 0
    s_cbranch_scc1 L32
    s_branch L29
L31:
    v_mov_b32 v2, 524
    s_mov_b32 s8, 0
Llw33:
    ds_read_b32 v3, v2
    s_add_u32 s8, s8, 1
    s_waitcnt lgkmcnt(0)
    v_readfirstlane_b32 s9, v3
    s_cmp_gt_u32 s8, 1600000
    s_cbranch_scc1 Llwd34
    s_cmp_lt_u32 s9, 8
    s_cbranch_scc1 Llw33
Llwd34:
    s_mul_i32 s16, s82, 44032
    s_mul_i32 s13, s7, 192
    s_add_u32 s16, s16, s13
    s_mul_i32 s18, s82, 3072
    s_add_u32 s18, s18, 6144
    s_add_u32 s13, s16, 0
    s_add_u32 m0, s18, 0
    s_nop 0
    buffer_load_dwordx4 v8, s[52:55], s13 offen lds
    s_add_u32 s13, s16, 0
    s_add_u32 m0, s18, 1024
    s_nop 0
    buffer_load_dwordx4 v9, s[52:55], s13 offen lds
    s_add_u32 s13, s16, 0
    s_add_u32 m0, s18, 2048
    s_nop 0
    buffer_load_dwordx4 v10, s[52:55], s13 offen lds
    s_add_u32 s13, s16, 176128
    s_add_u32 m0, s18, 12288
    s_nop 0
    buffer_load_dwordx4 v8, s[52:55], s13 offen lds
    s_add_u32 s13, s16, 176128
    s_add_u32 m0, s18, 13312
    s_nop 0
    buffer_load_dwordx4 v9, s[52:55], s13 offen lds
    s_add_u32 s13, s16, 176128
    s_add_u32 m0, s18, 14336
    s_nop 0
    buffer_load_dwordx4 v10, s[52:55], s13 offen lds
    s_add_u32 s13, s16, 352256
    s_add_u32 m0, s18, 24576
    s_nop 0
    buffer_load_dwordx4 v8, s[52:55], s13 offen lds
    s_add_u32 s13, s16, 352256
    s_add_u32 m0, s18, 25600
    s_nop 0
    buffer_load_dwordx4 v9, s[52:55], s13 offen lds
    s_add_u32 s13, s16, 352256
    s_add_u32 m0, s18, 26624
    s_nop 0
    buffer_load_dwordx4 v10, s[52:55], s13 offen lds
    s_cmp_eq_u32 s82, 3
    s_cbranch_scc1 L29
    s_add_u32 s13, s16, 528384
    s_add_u32 m0, s18, 36864
    s_nop 0
    buffer_load_dwordx4 v8, s[52:55], s13 offen lds
    s_add_u32 s13, s16, 528384
    s_add_u32 m0, s18, 37888
    s_nop 0
    buffer_load_dwordx4 v9, s[52:55], s13 offen lds
    s_add_u32 s13, s16, 528384
    s_add_u32 m0, s18, 38912
    s_nop 0
    buffer_load_dwordx4 v10, s[52:55], s13 offen lds
L29:
    s_cmp_eq_u32 s82, 3
    s_cbranch_scc1 L28
    s_mul_i32 s26, s38, 23392
    s_lshl_b32 s13, s82, 13
    s_add_u32 s26, s26, s13
    s_add_u32 s26, s26, 660480
    s_add_u32 s13, s26, 0
    buffer_load_dword v239, v245, s[52:55], s13 offen
L28:
    s_lshr_b32 s13, s3, 1
    s_cmp_lg_u32 s13, 2
    s_cbranch_scc1 L35
    s_mul_i32 s26, s38, 7680
    s_mul_i32 s13, s80, 704512
    s_add_u32 s26, s26, s13
    s_add_u32 s13, s26, 0
    buffer_load_dword v239, v245, s[60:63], s13 offen
L35:
    v_mov_b32 v2, 532
    s_mov_b32 s8, 0
Llw36:
    ds_read_b32 v3, v2
    s_add_u32 s8, s8, 1
    s_waitcnt lgkmcnt(0)
    v_readfirstlane_b32 s9, v3
    s_cmp_gt_u32 s8, 1600000
    s_cbranch_scc1 Llwd37
    s_cmp_lt_u32 s9, 4
    s_cbranch_scc1 Llw36
Llwd37:
L30:
    s_cmp_gt_u32 s20, 7
    s_cbranch_scc1 Ltail26
    ds_read_b128 v[192:195], v236 offset:29568
    ds_read_b128 v[196:199], v236 offset:30624
    ds_read_b128 v[184:187], v236 offset:25344
    ds_read_b128 v[188:191], v236 offset:26400
    v_exp_f32 v112, v112
    v_exp_f32 v113, v113
    v_cvt_pk_bf16_f32 v178, v108, v109
    v_cvt_pk_bf16_f32 v179, v110, v111
    v_exp_f32 v114, v114
    v_exp_f32 v115, v115
    v_mfma_f32_32x32x16_bf16 v[120:135], v[36:39], v[52:55], v[136:151]
    v_exp_f32 v116, v116
    v_exp_f32 v117, v117
    v_exp_f32 v118, v118
    v_exp_f32 v119, v119
    v_cvt_pk_bf16_f32 v180, v112, v113
    v_cvt_pk_bf16_f32 v181, v114, v115
    v_cvt_pk_bf16_f32 v182, v116, v117
    v_cvt_pk_bf16_f32 v183, v118, v119
    s_cmp_gt_u32 s20, 6
    s_cbranch_scc1 Ltail38
    v_exp_f32 v88, v88
    v_exp_f32 v89, v89
    v_exp_f32 v90, v90
    v_exp_f32 v91, v91
    s_waitcnt lgkmcnt(2)
    v_mfma_f32_32x32x16_bf16 v[152:167], v[192:195], v[176:179], v[152:167]
    v_exp_f32 v92, v92
    v_exp_f32 v93, v93
    v_cvt_pk_bf16_f32 v168, v88, v89
    v_cvt_pk_bf16_f32 v169, v90, v91
    v_exp_f32 v94, v94
    v_exp_f32 v95, v95
    v_mfma_f32_32x32x16_bf16 v[152:167], v[196:199], v[180:183], v[152:167]
    ds_read_b128 v[200:203], v236 offset:21120
    ds_read_b128 v[204:207], v236 offset:22176
    v_exp_f32 v96, v96
    v_exp_f32 v97, v97
    v_cvt_pk_bf16_f32 v170, v92, v93
    v_cvt_pk_bf16_f32 v171, v94, v95
    v_exp_f32 v98, v98
    v_exp_f32 v99, v99
    v_mfma_f32_32x32x16_bf16 v[104:119], v[32:35], v[52:55], v[136:151]
    v_exp_f32 v100, v100
    v_exp_f32 v101, v101
    v_exp_f32 v102, v102
    v_exp_f32 v103, v103
    v_cvt_pk_bf16_f32 v172, v96, v97
    v_cvt_pk_bf16_f32 v173, v98, v99
    v_cvt_pk_bf16_f32 v174, v100, v101
    v_cvt_pk_bf16_f32 v175, v102, v103
    s_cmp_gt_u32 s20, 5
    s_cbranch_scc1 Ltail39
    v_exp_f32 v120, v120
    v_exp_f32 v121, v121
    v_exp_f32 v122, v122
    v_exp_f32 v123, v123
    s_waitcnt lgkmcnt(2)
    v_mfma_f32_32x32x16_bf16 v[152:167], v[184:187], v[168:171], v[152:167]
    v_exp_f32 v124, v124
    v_exp_f32 v125, v125
    v_cvt_pk_bf16_f32 v176, v120, v121
    v_cvt_pk_bf16_f32 v177, v122, v123
    v_exp_f32 v126, v126
    v_exp_f32 v127, v127
    v_mfma_f32_32x32x16_bf16 v[152:167], v[188:191], v[172:175], v[152:167]
    ds_read_b128 v[192:195], v236 offset:16896
    ds_read_b128 v[196:199], v236 offset:17952
    v_exp_f32 v128, v128
    v_exp_f32 v129, v129
    v_cvt_pk_bf16_f32 v178, v124, v125
    v_cvt_pk_bf16_f32 v179, v126, v127
    v_exp_f32 v130, v130
    v_exp_f32 v131, v131
    v_mfma_f32_32x32x16_bf16 v[88:103], v[28:31], v[52:55], v[136:151]
    v_exp_f32 v132, v132
    v_exp_f32 v133, v133
    v_exp_f32 v134, v134
    v_exp_f32 v135, v135
    v_cvt_pk_bf16_f32 v180, v128, v129
    v_cvt_pk_bf16_f32 v181, v130, v131
    v_cvt_pk_bf16_f32 v182, v132, v133
    v_cvt_pk_bf16_f32 v183, v134, v135
    s_cmp_gt_u32 s20, 4
    s_cbranch_scc1 Ltail40
    v_exp_f32 v104, v104
    v_exp_f32 v105, v105
    v_exp_f32 v106, v106
    v_exp_f32 v107, v107
    s_waitcnt lgkmcnt(2)
    v_mfma_f32_32x32x16_bf16 v[152:167], v[200:203], v[176:179], v[152:167]
    v_exp_f32 v108, v108
    v_exp_f32 v109, v109
    v_cvt_pk_bf16_f32 v168, v104, v105
    v_cvt_pk_bf16_f32 v169, v106, v107
    v_exp_f32 v110, v110
    v_exp_f32 v111, v111
    v_mfma_f32_32x32x16_bf16 v[152:167], v[204:207], v[180:183], v[152:167]
    ds_read_b128 v[184:187], v236 offset:12672
    ds_read_b128 v[188:191], v236 offset:13728
    v_exp_f32 v112, v112
    v_exp_f32 v113, v113
    v_cvt_pk_bf16_f32 v170, v108, v109
    v_cvt_pk_bf16_f32 v171, v110, v111
    v_exp_f32 v114, v114
    v_exp_f32 v115, v115
    v_mfma_f32_32x32x16_bf16 v[120:135], v[24:27], v[52:55], v[136:151]
    v_exp_f32 v116, v116
    v_exp_f32 v117, v117
    v_exp_f32 v118, v118
    v_exp_f32 v119, v119
    v_cvt_pk_bf16_f32 v172, v112, v113
    v_cvt_pk_bf16_f32 v173, v114, v115
    v_cvt_pk_bf16_f32 v174, v116, v117
    v_cvt_pk_bf16_f32 v175, v118, v119
    s_cmp_gt_u32 s20, 3
    s_cbranch_scc1 Ltail41
    v_exp_f32 v88, v88
    v_exp_f32 v89, v89
    v_exp_f32 v90, v90
    v_exp_f32 v91, v91
    s_waitcnt lgkmcnt(2)
    v_mfma_f32_32x32x16_bf16 v[152:167], v[192:195], v[168:171], v[152:167]
    v_exp_f32 v92, v92
    v_exp_f32 v93, v93
    v_cvt_pk_bf16_f32 v176, v88, v89
    v_cvt_pk_bf16_f32 v177, v90, v91
    v_exp_f32 v94, v94
    v_exp_f32 v95, v95
    v_mfma_f32_32x32x16_bf16 v[152:167], v[196:199], v[172:175], v[152:167]
    ds_read_b128 v[200:203], v236 offset:8448
    ds_read_b128 v[204:207], v236 offset:9504
    v_exp_f32 v96, v96
    v_exp_f32 v97, v97
    v_cvt_pk_bf16_f32 v178, v92, v93
    v_cvt_pk_bf16_f32 v179, v94, v95
    v_exp_f32 v98, v98
    v_exp_f32 v99, v99
    v_mfma_f32_32x32x16_bf16 v[104:119], v[20:23], v[52:55], v[136:151]
    v_exp_f32 v100, v100
    v_exp_f32 v101, v101
    v_exp_f32 v102, v102
    v_exp_f32 v103, v103
    v_cvt_pk_bf16_f32 v180, v96, v97
    v_cvt_pk_bf16_f32 v181, v98, v99
    v_cvt_pk_bf16_f32 v182, v100, v101
    v_cvt_pk_bf16_f32 v183, v102, v103
    s_cmp_gt_u32 s20, 2
    s_cbranch_scc1 Ltail42
    v_exp_f32 v120, v120
    v_exp_f32 v121, v121
    v_exp_f32 v122, v122
    v_exp_f32 v123, v123
    s_waitcnt lgkmcnt(2)
    v_mfma_f32_32x32x16_bf16 v[152:167], v[184:187], v[176:179], v[152:167]
    v_exp_f32 v124, v124
    v_exp_f32 v125, v125
    v_cvt_pk_bf16_f32 v168, v120, v121
    v_cvt_pk_bf16_f32 v169, v122, v123
    v_exp_f32 v126, v126
    v_exp_f32 v127, v127
    v_mfma_f32_32x32x16_bf16 v[152:167], v[188:191], v[180:183], v[152:167]
    ds_read_b128 v[192:195], v236 offset:4224
    ds_read_b128 v[196:199], v236 offset:5280
    v_exp_f32 v128, v128
    v_exp_f32 v129, v129
    v_cvt_pk_bf16_f32 v170, v124, v125
    v_cvt_pk_bf16_f32 v171, v126, v127
    v_exp_f32 v130, v130
    v_exp_f32 v131, v131
    v_mfma_f32_32x32x16_bf16 v[88:103], v[16:19], v[52:55], v[72:87]
    v_exp_f32 v132, v132
    v_exp_f32 v133, v133
    v_exp_f32 v134, v134
    v_exp_f32 v135, v135
    v_cvt_pk_bf16_f32 v172, v128, v129
    v_cvt_pk_bf16_f32 v173, v130, v131
    v_cvt_pk_bf16_f32 v174, v132, v133
    v_cvt_pk_bf16_f32 v175, v134, v135
    s_cmp_gt_u32 s20, 1
    s_cbranch_scc1 Ltail43
    v_exp_f32 v104, v104
    v_exp_f32 v105, v105
    v_exp_f32 v106, v106
    v_exp_f32 v107, v107
    s_waitcnt lgkmcnt(2)
    v_mfma_f32_32x32x16_bf16 v[152:167], v[200:203], v[168:171], v[152:167]
    v_exp_f32 v108, v108
    v_exp_f32 v109, v109
    v_cvt_pk_bf16_f32 v176, v104, v105
    v_cvt_pk_bf16_f32 v177, v106, v107
    v_exp_f32 v110, v110
    v_exp_f32 v111, v111
    v_mfma_f32_32x32x16_bf16 v[152:167], v[204:207], v[172:175], v[152:167]
    ds_read_b128 v[184:187], v236 offset:0
    ds_read_b128 v[188:191], v236 offset:1056
    v_exp_f32 v112, v112
    v_exp_f32 v113, v113
    v_cvt_pk_bf16_f32 v178, v108, v109
    v_cvt_pk_bf16_f32 v179, v110, v111
    v_exp_f32 v114, v114
    v_exp_f32 v115, v115
    v_exp_f32 v116, v116
    v_exp_f32 v117, v117
    v_exp_f32 v118, v118
    v_exp_f32 v119, v119
    v_cvt_pk_bf16_f32 v180, v112, v113
    v_cvt_pk_bf16_f32 v181, v114, v115
    v_cvt_pk_bf16_f32 v182, v116, v117
    v_cvt_pk_bf16_f32 v183, v118, v119
    s_cmp_gt_u32 s20, 0
    s_cbranch_scc1 Ltail44
    v_exp_f32 v88, v88
    v_exp_f32 v89, v89
    v_exp_f32 v90, v90
    v_exp_f32 v91, v91
    s_waitcnt lgkmcnt(2)
    v_mfma_f32_32x32x16_bf16 v[152:167], v[192:195], v[176:179], v[152:167]
    v_exp_f32 v92, v92
    v_exp_f32 v93, v93
    v_cvt_pk_bf16_f32 v168, v88, v89
    v_cvt_pk_bf16_f32 v169, v90, v91
    v_exp_f32 v94, v94
    v_exp_f32 v95, v95
    v_mfma_f32_32x32x16_bf16 v[152:167], v[196:199], v[180:183], v[152:167]
    v_exp_f32 v96, v96
    v_exp_f32 v97, v97
    v_cvt_pk_bf16_f32 v170, v92, v93
    v_cvt_pk_bf16_f32 v171, v94, v95
    v_exp_f32 v98, v98
    v_exp_f32 v99, v99
    v_exp_f32 v100, v100
    v_exp_f32 v101, v101
    v_exp_f32 v102, v102
    v_exp_f32 v103, v103
    v_cvt_pk_bf16_f32 v172, v96, v97
    v_cvt_pk_bf16_f32 v173, v98, v99
    v_cvt_pk_bf16_f32 v174, v100, v101
    v_cvt_pk_bf16_f32 v175, v102, v103
    s_waitcnt lgkmcnt(0)
    v_mfma_f32_32x32x16_bf16 v[152:167], v[184:187], v[168:171], v[152:167]
    v_mfma_f32_32x32x16_bf16 v[152:167], v[188:191], v[172:175], v[152:167]
    s_branch Lattdone45
Ltail26:
    s_waitcnt lgkmcnt(0)
    s_nop 5
    v_mfma_f32_32x32x16_bf16 v[152:167], v[200:203], v[168:171], 0
    v_mfma_f32_32x32x16_bf16 v[152:167], v[204:207], v[172:175], v[152:167]
    s_branch Lattdone45
Ltail38:
    s_waitcnt lgkmcnt(0)
    v_mfma_f32_32x32x16_bf16 v[152:167], v[192:195], v[176:179], v[152:167]
    v_mfma_f32_32x32x16_bf16 v[152:167], v[196:199], v[180:183], v[152:167]
    s_branch Lattdone45
Ltail39:
    s_waitcnt lgkmcnt(0)
    v_mfma_f32_32x32x16_bf16 v[152:167], v[184:187], v[168:171], v[152:167]
    v_mfma_f32_32x32x16_bf16 v[152:167], v[188:191], v[172:175], v[152:167]
    s_branch Lattdone45
Ltail40:
    s_waitcnt lgkmcnt(0)
    v_mfma_f32_32x32x16_bf16 v[152:167], v[200:203], v[176:179], v[152:167]
    v_mfma_f32_32x32x16_bf16 v[152:167], v[204:207], v[180:183], v[152:167]
    s_branch Lattdone45
Ltail41:
    s_waitcnt lgkmcnt(0)
    v_mfma_f32_32x32x16_bf16 v[152:167], v[192:195], v[168:171], v[152:167]
    v_mfma_f32_32x32x16_bf16 v[152:167], v[196:199], v[172:175], v[152:167]
    s_branch Lattdone45
Ltail42:
    s_waitcnt lgkmcnt(0)
    v_mfma_f32_32x32x16_bf16 v[152:167], v[184:187], v[176:179], v[152:167]
    v_mfma_f32_32x32x16_bf16 v[152:167], v[188:191], v[180:183], v[152:167]
    s_branch Lattdone45
Ltail43:
    s_waitcnt lgkmcnt(0)
    v_mfma_f32_32x32x16_bf16 v[152:167], v[200:203], v[168:171], v[152:167]
    v_mfma_f32_32x32x16_bf16 v[152:167], v[204:207], v[172:175], v[152:167]
    s_branch Lattdone45
Ltail44:
    s_waitcnt lgkmcnt(0)
    v_mfma_f32_32x32x16_bf16 v[152:167], v[192:195], v[176:179], v[152:167]
    v_mfma_f32_32x32x16_bf16 v[152:167], v[196:199], v[180:183], v[152:167]
    s_branch Lattdone45
Lfb:
    s_mov_b32 s31, 1
    v_mov_b32 v210, v232
    v_mov_b32 v211, v233
    v_and_b32 v232, 31, v0
    v_lshrrev_b32 v233, 5, v0
    v_lshlrev_b32 v233, 2, v233
    v_sub_u32 v232, v232, v233
    v_mov_b32 v234, 0xff800000
    v_mov_b32 v235, 0
    v_cmp_le_i32 vcc, 0, v232
    s_nop 1
    v_cndmask_b32 v56, v234, v235, vcc
    v_cndmask_b32 v72, v235, v234, vcc
    v_cmp_le_i32 vcc, 1, v232
    s_nop 1
    v_cndmask_b32 v57, v234, v235, vcc
    v_cndmask_b32 v73, v235, v234, vcc
    v_cmp_le_i32 vcc, 2, v232
    s_nop 1
    v_cndmask_b32 v58, v234, v235, vcc
    v_cndmask_b32 v74, v235, v234, vcc
    v_cmp_le_i32 vcc, 3, v232
    s_nop 1
    v_cndmask_b32 v59, v234, v235, vcc
    v_cndmask_b32 v75, v235, v234, vcc
    v_cmp_le_i32 vcc, 8, v232
    s_nop 1
    v_cndmask_b32 v60, v234, v235, vcc
    v_cndmask_b32 v76, v235, v234, vcc
    v_cmp_le_i32 vcc, 9, v232
    s_nop 1
    v_cndmask_b32 v61, v234, v235, vcc
    v_cndmask_b32 v77, v235, v234, vcc
    v_cmp_le_i32 vcc, 10, v232
    s_nop 1
    v_cndmask_b32 v62, v234, v235, vcc
    v_cndmask_b32 v78, v235, v234, vcc
    v_cmp_le_i32 vcc, 11, v232
    s_nop 1
    v_cndmask_b32 v63, v234, v235, vcc
    v_cndmask_b32 v79, v235, v234, vcc
    v_cmp_le_i32 vcc, 16, v232
    s_nop 1
    v_cndmask_b32 v64, v234, v235, vcc
    v_cndmask_b32 v80, v235, v234, vcc
    v_cmp_le_i32 vcc, 17, v232
    s_nop 1
    v_cndmask_b32 v65, v234, v235, vcc
    v_cndmask_b32 v81, v235, v234, vcc
    v_cmp_le_i32 vcc, 18, v232
    s_nop 1
    v_cndmask_b32 v66, v234, v235, vcc
    v_cndmask_b32 v82, v235, v234, vcc
    v_cmp_le_i32 vcc, 19, v232
    s_nop 1
    v_cndmask_b32 v67, v234, v235, vcc
    v_cndmask_b32 v83, v235, v234, vcc
    v_cmp_le_i32 vcc, 24, v232
    s_nop 1
    v_cndmask_b32 v68, v234, v235, vcc
    v_cndmask_b32 v84, v235, v234, vcc
    v_cmp_le_i32 vcc, 25, v232
    s_nop 1
    v_cndmask_b32 v69, v234, v235, vcc
    v_cndmask_b32 v85, v235, v234, vcc
    v_cmp_le_i32 vcc, 26, v232
    s_nop 1
    v_cndmask_b32 v70, v234, v235, vcc
    v_cndmask_b32 v86, v235, v234, vcc
    v_cmp_le_i32 vcc, 27, v232
    s_nop 1
    v_cndmask_b32 v71, v234, v235, vcc
    v_cndmask_b32 v87, v235, v234, vcc
    v_mov_b32 v232, v210
    v_mov_b32 v233, v211
    v_mov_b32 v238, 0xff800000
    v_mov_b32 v237, 0xff800000
    s_cmp_gt_u32 s20, 0
    s_cbranch_scc1 L46
    v_mfma_f32_32x32x16_bf16 v[120:135], v[16:19], v[52:55], v[72:87]
    s_nop 11
    v_max3_f32 v238, v120, v121, v238
    v_max3_f32 v237, v122, v123, v237
    v_max3_f32 v238, v124, v125, v238
    v_max3_f32 v237, v126, v127, v237
    v_max3_f32 v238, v128, v129, v238
    v_max3_f32 v237, v130, v131, v237
    v_max3_f32 v238, v132, v133, v238
    v_max3_f32 v237, v134, v135, v237
L46:
    s_cmp_gt_u32 s20, 1
    s_cbranch_scc1 L47
    v_mfma_f32_32x32x16_bf16 v[120:135], v[20:23], v[52:55], 0
    s_nop 11
    v_max3_f32 v238, v120, v121, v238
    v_max3_f32 v237, v122, v123, v237
    v_max3_f32 v238, v124, v125, v238
    v_max3_f32 v237, v126, v127, v237
    v_max3_f32 v238, v128, v129, v238
    v_max3_f32 v237, v130, v131, v237
    v_max3_f32 v238, v132, v133, v238
    v_max3_f32 v237, v134, v135, v237
L47:
    s_cmp_gt_u32 s20, 2
    s_cbranch_scc1 L48
    v_mfma_f32_32x32x16_bf16 v[120:135], v[24:27], v[52:55], 0
    s_nop 11
    v_max3_f32 v238, v120, v121, v238
    v_max3_f32 v237, v122, v123, v237
    v_max3_f32 v238, v124, v125, v238
    v_max3_f32 v237, v126, v127, v237
    v_max3_f32 v238, v128, v129, v238
    v_max3_f32 v237, v130, v131, v237
    v_max3_f32 v238, v132, v133, v238
    v_max3_f32 v237, v134, v135, v237
L48:
    s_cmp_gt_u32 s20, 3
    s_cbranch_scc1 L49
    v_mfma_f32_32x32x16_bf16 v[120:135], v[28:31], v[52:55], 0
    s_nop 11
    v_max3_f32 v238, v120, v121, v238
    v_max3_f32 v237, v122, v123, v237
    v_max3_f32 v238, v124, v125, v238
    v_max3_f32 v237, v126, v127, v237
    v_max3_f32 v238, v128, v129, v238
    v_max3_f32 v237, v130, v131, v237
    v_max3_f32 v238, v132, v133, v238
    v_max3_f32 v237, v134, v135, v237
L49:
    s_cmp_gt_u32 s20, 4
    s_cbranch_scc1 L50
    v_mfma_f32_32x32x16_bf16 v[120:135], v[32:35], v[52:55], 0
    s_nop 11
    v_max3_f32 v238, v120, v121, v238
    v_max3_f32 v237, v122, v123, v237
    v_max3_f32 v238, v124, v125, v238
    v_max3_f32 v237, v126, v127, v237
    v_max3_f32 v238, v128, v129, v238
    v_max3_f32 v237, v130, v131, v237
    v_max3_f32 v238, v132, v133, v238
    v_max3_f32 v237, v134, v135, v237
L50:
    s_cmp_gt_u32 s20, 5
    s_cbranch_scc1 L51
    v_mfma_f32_32x32x16_bf16 v[120:135], v[36:39], v[52:55], 0
    s_nop 11
    v_max3_f32 v238, v120, v121, v238
    v_max3_f32 v237, v122, v123, v237
    v_max3_f32 v238, v124, v125, v238
    v_max3_f32 v237, v126, v127, v237
    v_max3_f32 v238, v128, v129, v238
    v_max3_f32 v237, v130, v131, v237
    v_max3_f32 v238, v132, v133, v238
    v_max3_f32 v237, v134, v135, v237
L51:
    s_cmp_gt_u32 s20, 6
    s_cbranch_scc1 L52
    v_mfma_f32_32x32x16_bf16 v[120:135], v[40:43], v[52:55], 0
    s_nop 11
    v_max3_f32 v238, v120, v121, v238
    v_max3_f32 v237, v122, v123, v237
    v_max3_f32 v238, v124, v125, v238
    v_max3_f32 v237, v126, v127, v237
    v_max3_f32 v238, v128, v129, v238
    v_max3_f32 v237, v130, v131, v237
    v_max3_f32 v238, v132, v133, v238
    v_max3_f32 v237, v134, v135, v237
L52:
    s_cmp_gt_u32 s20, 7
    s_cbranch_scc1 L53
    v_mfma_f32_32x32x16_bf16 v[120:135], v[44:47], v[52:55], 0
    s_nop 11
    v_max3_f32 v238, v120, v121, v238
    v_max3_f32 v237, v122, v123, v237
    v_max3_f32 v238, v124, v125, v238
    v_max3_f32 v237, v126, v127, v237
    v_max3_f32 v238, v128, v129, v238
    v_max3_f32 v237, v130, v131, v237
    v_max3_f32 v238, v132, v133, v238
    v_max3_f32 v237, v134, v135, v237
L53:
    v_mfma_f32_32x32x16_bf16 v[120:135], v[48:51], v[52:55], v[56:71]
    s_nop 11
    v_max3_f32 v238, v120, v121, v238
    v_max3_f32 v237, v122, v123, v237
    v_max3_f32 v238, v124, v125, v238
    v_max3_f32 v237, v126, v127, v237
    v_max3_f32 v238, v128, v129, v238
    v_max3_f32 v237, v130, v131, v237
    v_max3_f32 v238, v132, v133, v238
    v_max3_f32 v237, v134, v135, v237
    v_max_f32 v238, v238, v237
    v_mov_b32 v237, v238
    s_nop 1
    v_permlane32_swap_b32 v238, v237
    v_max_f32 v238, v238, v237
    s_branch Lp2
Lattdone45:
    v_mov_b32 v237, 0x5f800000
    s_nop 9
    v_cmp_nlt_f32 vcc, v160, v237
    s_cmp_lg_u32 s31, 0
    s_cselect_b64 vcc, 0, vcc
    s_cbranch_vccnz Lfb
    s_lshl_b32 s13, s22, 10
    s_add_u32 s13, s13, 4194304
    s_add_u32 s22, s22, 1024
    v_rcp_f32 v238, v160
    s_nop 0
    v_pk_mul_f32 v[152:153], v[152:153], v[238:239] op_sel_hi:[1,0]
    v_pk_mul_f32 v[154:155], v[154:155], v[238:239] op_sel_hi:[1,0]
    v_pk_mul_f32 v[156:157], v[156:157], v[238:239] op_sel_hi:[1,0]
    v_pk_mul_f32 v[158:159], v[158:159], v[238:239] op_sel_hi:[1,0]
    v_cvt_pk_bf16_f32 v168, v152, v153
    v_cvt_pk_bf16_f32 v169, v154, v155
    v_cvt_pk_bf16_f32 v170, v156, v157
    v_cvt_pk_bf16_f32 v171, v158, v159
    buffer_store_dwordx4 v[168:171], v232, s[72:75], s13 offen sc1
    s_waitcnt vmcnt(0)
    s_lshl_b32 s9, s22, 7
    s_add_u32 s9, s9, 16777216
    v_mov_b32 v6, s9
    v_mov_b32 v7, 1
    s_mov_b64 exec, 1
    s_cmp_eq_u32 s83, 0
    s_cbranch_scc1 Lsl55
    buffer_store_dword v7, v6, s[72:75], 0 offen
    s_branch Lsd56
Lsl55:
    buffer_store_dword v7, v6, s[72:75], 0 offen sc1
Lsd56:
    s_mov_b64 exec, -1
    s_setprio 0
    s_cmp_ge_u32 s3, 4
    s_cbranch_scc1 Lloader2
    v_mov_b32 v2, 528
    v_mov_b32 v3, 1
    s_mov_b64 exec, 1
    ds_add_u32 v2, v3
    s_mov_b64 exec, -1
    v_mov_b32 v2, 528
    s_mov_b32 s8, 0
Llw57:
    ds_read_b32 v3, v2
    s_add_u32 s8, s8, 1
    s_waitcnt lgkmcnt(0)
    v_readfirstlane_b32 s9, v3
    s_cmp_gt_u32 s8, 1600000
    s_cbranch_scc1 Llwd58
    s_cmp_lt_u32 s9, 4
    s_cbranch_scc1 Llw57
Llwd58:
Ls3:
    v_lshrrev_b32 v2, 5, v0
    v_mul_u32_u24 v2, 4, v2
    v_bfe_u32 v4, v0, 2, 2
    v_add_u32 v2, v2, v4
    v_mul_u32_u24 v2, 128, v2
    v_bfe_u32 v4, v0, 3, 1
    v_xor_b32 v4, s81, v4
    v_lshl_add_u32 v2, v4, 6, v2
    v_bfe_u32 v4, v0, 4, 1
    v_lshl_add_u32 v2, v4, 5, v2
    v_and_b32 v4, 3, v0
    v_lshl_add_u32 v2, v4, 3, v2
    s_lshl_b32 s13, s81, 15
    s_add_u32 s13, s13, 98304
    v_add_u32 v2, s13, v2
    v_xor_b32 v3, 64, v2
    ds_read_b64_tr_b16 v[112:113], v2 offset:0
    ds_read_b64_tr_b16 v[114:115], v2 offset:1024
    ds_read_b64_tr_b16 v[116:117], v3 offset:0
    ds_read_b64_tr_b16 v[118:119], v3 offset:1024
    ds_read_b64_tr_b16 v[120:121], v2 offset:2048
    ds_read_b64_tr_b16 v[122:123], v2 offset:3072
    ds_read_b64_tr_b16 v[124:125], v3 offset:2048
    ds_read_b64_tr_b16 v[126:127], v3 offset:3072
    ds_read_b64_tr_b16 v[128:129], v2 offset:4096
    ds_read_b64_tr_b16 v[130:131], v2 offset:5120
    ds_read_b64_tr_b16 v[132:133], v3 offset:4096
    ds_read_b64_tr_b16 v[134:135], v3 offset:5120
    ds_read_b64_tr_b16 v[136:137], v2 offset:6144
    ds_read_b64_tr_b16 v[138:139], v2 offset:7168
    ds_read_b64_tr_b16 v[140:141], v3 offset:6144
    ds_read_b64_tr_b16 v[142:143], v3 offset:7168
    ds_read_b64_tr_b16 v[144:145], v2 offset:8192
    ds_read_b64_tr_b16 v[146:147], v2 offset:9216
    ds_read_b64_tr_b16 v[148:149], v3 offset:8192
    ds_read_b64_tr_b16 v[150:151], v3 offset:9216
    ds_read_b64_tr_b16 v[152:153], v2 offset:10240
    ds_read_b64_tr_b16 v[154:155], v2 offset:11264
    ds_read_b64_tr_b16 v[156:157], v3 offset:10240
    ds_read_b64_tr_b16 v[158:159], v3 offset:11264
    ds_read_b64_tr_b16 v[160:161], v2 offset:12288
    ds_read_b64_tr_b16 v[162:163], v2 offset:13312
    ds_read_b64_tr_b16 v[164:165], v3 offset:12288
    ds_read_b64_tr_b16 v[166:167], v3 offset:13312
    ds_read_b64_tr_b16 v[168:169], v2 offset:14336
    ds_read_b64_tr_b16 v[170:171], v2 offset:15360
    ds_read_b64_tr_b16 v[172:173], v3 offset:14336
    ds_read_b64_tr_b16 v[174:175], v3 offset:15360
    ds_read_b64_tr_b16 v[176:177], v2 offset:16384
    ds_read_b64_tr_b16 v[178:179], v2 offset:17408
    ds_read_b64_tr_b16 v[180:181], v3 offset:16384
    ds_read_b64_tr_b16 v[182:183], v3 offset:17408
    ds_read_b64_tr_b16 v[184:185], v2 offset:18432
    ds_read_b64_tr_b16 v[186:187], v2 offset:19456
    ds_read_b64_tr_b16 v[188:189], v3 offset:18432
    ds_read_b64_tr_b16 v[190:191], v3 offset:19456
    ds_read_b64_tr_b16 v[192:193], v2 offset:20480
    ds_read_b64_tr_b16 v[194:195], v2 offset:21504
    ds_read_b64_tr_b16 v[196:197], v3 offset:20480
    ds_read_b64_tr_b16 v[198:199], v3 offset:21504
    ds_read_b64_tr_b16 v[200:201], v2 offset:22528
    ds_read_b64_tr_b16 v[202:203], v2 offset:23552
    ds_read_b64_tr_b16 v[204:205], v3 offset:22528
    ds_read_b64_tr_b16 v[206:207], v3 offset:23552
    ds_read_b64_tr_b16 v[208:209], v2 offset:24576
    ds_read_b64_tr_b16 v[210:211], v2 offset:25600
    ds_read_b64_tr_b16 v[212:213], v3 offset:24576
    ds_read_b64_tr_b16 v[214:215], v3 offset:25600
    ds_read_b64_tr_b16 v[216:217], v2 offset:26624
    ds_read_b64_tr_b16 v[218:219], v2 offset:27648
    ds_read_b64_tr_b16 v[220:221], v3 offset:26624
    ds_read_b64_tr_b16 v[222:223], v3 offset:27648
    ds_read_b64_tr_b16 v[224:225], v2 offset:28672
    ds_read_b64_tr_b16 v[226:227], v2 offset:29696
    ds_read_b64_tr_b16 v[228:229], v3 offset:28672
    ds_read_b64_tr_b16 v[230:231], v3 offset:29696
    ds_read_b64_tr_b16 v[232:233], v2 offset:30720
    ds_read_b64_tr_b16 v[234:235], v2 offset:31744
    ds_read_b64_tr_b16 v[236:237], v3 offset:30720
    ds_read_b64_tr_b16 v[238:239], v3 offset:31744
    s_lshl_b32 s13, s23, 5
    s_lshl_b32 s14, s81, 4
    s_add_u32 s13, s13, s14
    v_add_u32 v5, s13, v0
    v_lshlrev_b32 v5, 7, v5
    v_add_u32 v5, 16908288, v5
    s_lshl_b32 s16, s13, 10
    s_add_u32 s16, s16, 4194304
    v_lshlrev_b32 v244, 4, v0
    v_lshlrev_b32 v16, 16, v248
    v_and_b32 v17, 0xffff0000, v248
    v_lshlrev_b32 v18, 16, v249
    v_and_b32 v19, 0xffff0000, v249
    v_lshlrev_b32 v20, 16, v250
    v_and_b32 v21, 0xffff0000, v250
    v_lshlrev_b32 v22, 16, v251
    v_and_b32 v23, 0xffff0000, v251
    v_lshlrev_b32 v24, 16, v252
    v_and_b32 v25, 0xffff0000, v252
    v_lshlrev_b32 v26, 16, v253
    v_and_b32 v27, 0xffff0000, v253
    v_lshlrev_b32 v28, 16, v254
    v_and_b32 v29, 0xffff0000, v254
    v_lshlrev_b32 v30, 16, v255
    v_and_b32 v31, 0xffff0000, v255
    s_lshl_b32 s13, s3, 12
    s_add_u32 s13, s13, 102400
    v_add_u32 v12, s13, v244
    s_xor_b32 s13, s3, 2
    s_lshl_b32 s13, s13, 12
    s_add_u32 s13, s13, 102400
    v_add_u32 v13, s13, v244
    s_lshl_b32 s13, s5, 1
    s_add_u32 s13, s13, s81
    s_lshl_b32 s14, s23, 4
    s_add_u32 s14, s14, s13
    s_lshl_b32 s19, s14, 11
    s_add_u32 s19, s19, 6291456
    s_lshl_b32 s17, s14, 8
    s_add_u32 s17, s17, 8388608
    s_add_u32 s18, s14, 3072
    v_lshlrev_b32 v14, 2, v0
    v_mov_b32 v15, 0x3f803f80
    v_mov_b32 v8, 0
    v_mov_b32 v9, 0
    v_mov_b32 v10, 0
    v_mov_b32 v11, 0
    s_waitcnt lgkmcnt(0)
    s_barrier
    s_mov_b32 exec_lo, 0xffff
    s_mov_b32 exec_hi, 0
    s_mov_b32 s8, 0
Lpoll59:
    buffer_load_dword v6, v5, s[72:75], 0 offen sc1
    s_add_u32 s8, s8, 1
    s_waitcnt vmcnt(0)
    v_cmp_eq_u32 vcc, 0, v6
    s_cmp_gt_u32 s8, 400000
    s_cbranch_scc1 Lpd60
    s_cbranch_vccnz Lpoll59
Lpd60:
    s_mov_b64 exec, -1
    buffer_load_dwordx4 v[48:51], v244, s[72:75], s16 offen offset:0 sc1
    buffer_load_dwordx4 v[52:55], v244, s[72:75], s16 offen offset:1024 sc1
    buffer_load_dwordx4 v[56:59], v244, s[72:75], s16 offen offset:2048 sc1
    buffer_load_dwordx4 v[60:63], v244, s[72:75], s16 offen offset:3072 sc1
    s_add_u32 s16, s16, 4096
    buffer_load_dwordx4 v[64:67], v244, s[72:75], s16 offen offset:0 sc1
    buffer_load_dwordx4 v[68:71], v244, s[72:75], s16 offen offset:1024 sc1
    buffer_load_dwordx4 v[72:75], v244, s[72:75], s16 offen offset:2048 sc1
    buffer_load_dwordx4 v[76:79], v244, s[72:75], s16 offen offset:3072 sc1
    s_add_u32 s16, s16, 4096
    buffer_load_dwordx4 v[80:83], v244, s[72:75], s16 offen offset:0 sc1
    buffer_load_dwordx4 v[84:87], v244, s[72:75], s16 offen offset:1024 sc1
    buffer_load_dwordx4 v[88:91], v244, s[72:75], s16 offen offset:2048 sc1
    buffer_load_dwordx4 v[92:95], v244, s[72:75], s16 offen offset:3072 sc1
    s_waitcnt vmcnt(11)
    v_mfma_f32_32x32x16_bf16 v[32:47], v[116:119], v[48:51], 0
    s_add_u32 s16, s16, 4096
    buffer_load_dwordx4 v[96:99], v244, s[72:75], s16 offen offset:0 sc1
    v_mfma_f32_32x32x16_bf16 v[16:31], v[112:115], v[48:51], v[16:31]
    s_waitcnt vmcnt(11)
    v_mfma_f32_32x32x16_bf16 v[32:47], v[124:127], v[52:55], v[32:47]
    buffer_load_dwordx4 v[100:103], v244, s[72:75], s16 offen offset:1024 sc1
    v_mfma_f32_32x32x16_bf16 v[16:31], v[120:123], v[52:55], v[16:31]
    s_waitcnt vmcnt(11)
    v_mfma_f32_32x32x16_bf16 v[32:47], v[132:135], v[56:59], v[32:47]
    buffer_load_dwordx4 v[104:107], v244, s[72:75], s16 offen offset:2048 sc1
    v_mfma_f32_32x32x16_bf16 v[16:31], v[128:131], v[56:59], v[16:31]
    s_waitcnt vmcnt(11)
    v_mfma_f32_32x32x16_bf16 v[32:47], v[140:143], v[60:63], v[32:47]
    buffer_load_dwordx4 v[108:111], v244, s[72:75], s16 offen offset:3072 sc1
    v_mfma_f32_32x32x16_bf16 v[16:31], v[136:139], v[60:63], v[16:31]
    s_waitcnt vmcnt(11)
    v_mfma_f32_32x32x16_bf16 v[32:47], v[148:151], v[64:67], v[32:47]
    v_mfma_f32_32x32x16_bf16 v[16:31], v[144:147], v[64:67], v[16:31]
    s_waitcnt vmcnt(10)
    v_mfma_f32_32x32x16_bf16 v[32:47], v[156:159], v[68:71], v[32:47]
    v_mfma_f32_32x32x16_bf16 v[16:31], v[152:155], v[68:71], v[16:31]
    s_waitcnt vmcnt(9)
    v_mfma_f32_32x32x16_bf16 v[32:47], v[164:167], v[72:75], v[32:47]
    v_mfma_f32_32x32x16_bf16 v[16:31], v[160:163], v[72:75], v[16:31]
    s_waitcnt vmcnt(8)
    v_mfma_f32_32x32x16_bf16 v[32:47], v[172:175], v[76:79], v[32:47]
    v_mfma_f32_32x32x16_bf16 v[16:31], v[168:171], v[76:79], v[16:31]
    s_waitcnt vmcnt(7)
    v_mfma_f32_32x32x16_bf16 v[32:47], v[180:183], v[80:83], v[32:47]
    v_mfma_f32_32x32x16_bf16 v[16:31], v[176:179], v[80:83], v[16:31]
    s_waitcnt vmcnt(6)
    v_mfma_f32_32x32x16_bf16 v[32:47], v[188:191], v[84:87], v[32:47]
    v_mfma_f32_32x32x16_bf16 v[16:31], v[184:187], v[84:87], v[16:31]
    s_waitcnt vmcnt(5)
    v_mfma_f32_32x32x16_bf16 v[32:47], v[196:199], v[88:91], v[32:47]
    v_mfma_f32_32x32x16_bf16 v[16:31], v[192:195], v[88:91], v[16:31]
    s_waitcnt vmcnt(4)
    v_mfma_f32_32x32x16_bf16 v[32:47], v[204:207], v[92:95], v[32:47]
    v_mfma_f32_32x32x16_bf16 v[16:31], v[200:203], v[92:95], v[16:31]
    s_waitcnt vmcnt(3)
    v_mfma_f32_32x32x16_bf16 v[32:47], v[212:215], v[96:99], v[32:47]
    v_mfma_f32_32x32x16_bf16 v[16:31], v[208:211], v[96:99], v[16:31]
    s_waitcnt vmcnt(2)
    v_mfma_f32_32x32x16_bf16 v[32:47], v[220:223], v[100:103], v[32:47]
    v_mfma_f32_32x32x16_bf16 v[16:31], v[216:219], v[100:103], v[16:31]
    s_waitcnt vmcnt(1)
    v_mfma_f32_32x32x16_bf16 v[32:47], v[228:231], v[104:107], v[32:47]
    v_mfma_f32_32x32x16_bf16 v[16:31], v[224:227], v[104:107], v[16:31]
    s_waitcnt vmcnt(0)
    v_mfma_f32_32x32x16_bf16 v[32:47], v[236:239], v[108:111], v[32:47]
    v_mfma_f32_32x32x16_bf16 v[16:31], v[232:235], v[108:111], v[16:31]
    s_nop 10
    ds_write_b128 v12, v[32:35] offset:0
    ds_write_b128 v12, v[36:39] offset:1024
    ds_write_b128 v12, v[40:43] offset:2048
    ds_write_b128 v12, v[44:47] offset:3072
    s_waitcnt lgkmcnt(0)
    s_barrier
    ds_read_b128 v[32:35], v13 offset:0
    ds_read_b128 v[36:39], v13 offset:1024
    ds_read_b128 v[40:43], v13 offset:2048
    ds_read_b128 v[44:47], v13 offset:3072
    s_waitcnt lgkmcnt(3)
    v_pk_add_f32 v[16:17], v[16:17], v[32:33]
    v_pk_add_f32 v[18:19], v[18:19], v[34:35]
    v_cvt_pk_bf16_f32 v248, v16, v17
    v_cvt_pk_bf16_f32 v249, v18, v19
    s_waitcnt lgkmcnt(2)
    v_pk_add_f32 v[20:21], v[20:21], v[36:37]
    v_pk_add_f32 v[22:23], v[22:23], v[38:39]
    v_cvt_pk_bf16_f32 v250, v20, v21
    v_cvt_pk_bf16_f32 v251, v22, v23
    s_waitcnt lgkmcnt(1)
    v_pk_add_f32 v[24:25], v[24:25], v[40:41]
    v_pk_add_f32 v[26:27], v[26:27], v[42:43]
    v_cvt_pk_bf16_f32 v252, v24, v25
    v_cvt_pk_bf16_f32 v253, v26, v27
    s_waitcnt lgkmcnt(0)
    v_pk_add_f32 v[28:29], v[28:29], v[44:45]
    v_pk_add_f32 v[30:31], v[30:31], v[46:47]
    v_cvt_pk_bf16_f32 v254, v28, v29
    v_cvt_pk_bf16_f32 v255, v30, v31
    buffer_store_dwordx4 v[248:251], v244, s[72:75], s19 offen sc1
    buffer_store_dwordx4 v[252:255], v244, s[72:75], s19 offen offset:1024 sc1
    v_dot2c_f32_bf16 v8, v248, v15
    v_dot2c_f32_bf16 v10, v248, v248
    v_dot2c_f32_bf16 v9, v249, v15
    v_dot2c_f32_bf16 v11, v249, v249
    v_dot2c_f32_bf16 v8, v250, v15
    v_dot2c_f32_bf16 v10, v250, v250
    v_dot2c_f32_bf16 v9, v251, v15
    v_dot2c_f32_bf16 v11, v251, v251
    v_dot2c_f32_bf16 v8, v252, v15
    v_dot2c_f32_bf16 v10, v252, v252
    v_dot2c_f32_bf16 v9, v253, v15
    v_dot2c_f32_bf16 v11, v253, v253
    v_dot2c_f32_bf16 v8, v254, v15
    v_dot2c_f32_bf16 v10, v254, v254
    v_dot2c_f32_bf16 v9, v255, v15
    v_dot2c_f32_bf16 v11, v255, v255
    s_nop 1
    v_add_f32 v8, v8, v9
    v_add_f32 v10, v10, v11
    s_nop 1
    v_permlane32_swap_b32 v8, v10
    v_add_f32 v8, v8, v10
    buffer_store_dword v8, v14, s[72:75], s17 offen sc1
    s_lshl_b32 s25, s6, 2
    s_add_u32 s25, s25, s3
    s_lshl_b32 s13, s25, 4
    v_add_u32 v5, s13, v0
    v_lshlrev_b32 v5, 7, v5
    v_add_u32 v5, 17170432, v5
    v_lshrrev_b32 v2, 5, v0
    v_mul_u32_u24 v2, 4, v2
    v_bfe_u32 v4, v0, 2, 2
    v_add_u32 v2, v2, v4
    v_mul_u32_u24 v2, 192, v2
    v_bfe_u32 v4, v0, 4, 1
    v_lshl_add_u32 v2, v4, 5, v2
    v_and_b32 v4, 3, v0
    v_lshl_add_u32 v2, v4, 3, v2
    v_add_u32 v3, 49152, v2
    v_add_u32 v4, 99840, v244
    ds_read_b64_tr_b16 v[192:193], v2 offset:6144
    ds_read_b64_tr_b16 v[194:195], v2 offset:7680
    ds_read_b64_tr_b16 v[196:197], v2 offset:6208
    ds_read_b64_tr_b16 v[198:199], v2 offset:7744
    ds_read_b64_tr_b16 v[200:201], v2 offset:9216
    ds_read_b64_tr_b16 v[202:203], v2 offset:10752
    ds_read_b64_tr_b16 v[204:205], v2 offset:9280
    ds_read_b64_tr_b16 v[206:207], v2 offset:10816
    v_mov_b32 v232, 0
    v_mov_b32 v233, 0
    v_mov_b32 v234, 0
    v_mov_b32 v235, 0
    v_mov_b32 v236, 0
    v_mov_b32 v237, 0
    v_mov_b32 v238, 0
    v_mov_b32 v239, 0
    v_mov_b32 v240, 0
    v_mov_b32 v241, 0
    v_mov_b32 v242, 0
    v_mov_b32 v243, 0
    s_lshl_b32 s16, s25, 15
    s_add_u32 s16, s16, 6291456
    s_lshl_b32 s29, s25, 12
    s_add_u32 s29, s29, 8388608
    s_mul_i32 s17, s25, 86
    s_mul_i32 s13, s7, 6
    s_add_u32 s17, s17, s13
    s_lshl_b32 s17, s17, 10
    s_add_u32 s17, s17, 9437184
    s_add_u32 s19, s17, 4096
    s_lshl_b32 s30, s25, 4
    s_add_u32 s30, s30, s7
    s_add_u32 s30, s30, 4096
    s_waitcnt vmcnt(0)
    s_lshl_b32 s9, s18, 7
    s_add_u32 s9, s9, 16777216
    v_mov_b32 v6, s9
    v_mov_b32 v7, 1
    s_mov_b64 exec, 1
    s_cmp_eq_u32 s83, 0
    s_cbranch_scc1 Lsl61
    buffer_store_dword v7, v6, s[72:75], 0 offen
    s_branch Lsd62
Lsl61:
    buffer_store_dword v7, v6, s[72:75], 0 offen sc1
Lsd62:
    s_mov_b64 exec, -1
    s_cmp_eq_u32 s7, 15
    s_cbranch_scc1 Ls4skip
    v_lshlrev_b32 v7, 2, v0
    s_mov_b32 exec_lo, 0xffff
    s_mov_b32 exec_hi, 0
    s_mov_b32 s8, 0
Lpoll63:
    buffer_load_dword v6, v5, s[72:75], 0 offen sc1
    s_add_u32 s8, s8, 1
    s_waitcnt vmcnt(0)
    v_cmp_eq_u32 vcc, 0, v6
    s_cmp_gt_u32 s8, 400000
    s_cbranch_scc1 Lpd64
    s_cbranch_vccnz Lpoll63
Lpd64:
    s_mov_b64 exec, -1
    buffer_load_dwordx4 v[64:67], v244, s[72:75], s16 offen offset:0 sc1
    buffer_load_dwordx4 v[68:71], v244, s[72:75], s16 offen offset:1024 sc1
    buffer_load_dwordx4 v[72:75], v244, s[72:75], s16 offen offset:2048 sc1
    buffer_load_dwordx4 v[76:79], v244, s[72:75], s16 offen offset:3072 sc1
    buffer_load_dword v216, v7, s[72:75], s29 offen offset:0 sc1
    buffer_load_dword v217, v7, s[72:75], s29 offen offset:256 sc1
    buffer_load_dword v218, v7, s[72:75], s29 offen offset:512 sc1
    buffer_load_dword v219, v7, s[72:75], s29 offen offset:768 sc1
    buffer_load_dword v220, v7, s[72:75], s29 offen offset:1024 sc1
    buffer_load_dword v221, v7, s[72:75], s29 offen offset:1280 sc1
    buffer_load_dword v222, v7, s[72:75], s29 offen offset:1536 sc1
    buffer_load_dword v223, v7, s[72:75], s29 offen offset:1792 sc1
    buffer_load_dword v224, v7, s[72:75], s29 offen offset:2048 sc1
    buffer_load_dword v225, v7, s[72:75], s29 offen offset:2304 sc1
    buffer_load_dword v226, v7, s[72:75], s29 offen offset:2560 sc1
    buffer_load_dword v227, v7, s[72:75], s29 offen offset:2816 sc1
    buffer_load_dword v228, v7, s[72:75], s29 offen offset:3072 sc1
    buffer_load_dword v229, v7, s[72:75], s29 offen offset:3328 sc1
    buffer_load_dword v230, v7, s[72:75], s29 offen offset:3584 sc1
    buffer_load_dword v231, v7, s[72:75], s29 offen offset:3840 sc1
    s_add_u32 s16, s16, 4096
    buffer_load_dwordx4 v[80:83], v244, s[72:75], s16 offen offset:0 sc1
    buffer_load_dwordx4 v[84:87], v244, s[72:75], s16 offen offset:1024 sc1
    buffer_load_dwordx4 v[88:91], v244, s[72:75], s16 offen offset:2048 sc1
    buffer_load_dwordx4 v[92:95], v244, s[72:75], s16 offen offset:3072 sc1
    s_add_u32 s16, s16, 4096
    buffer_load_dwordx4 v[96:99], v244, s[72:75], s16 offen offset:0 sc1
    buffer_load_dwordx4 v[100:103], v244, s[72:75], s16 offen offset:1024 sc1
    buffer_load_dwordx4 v[104:107], v244, s[72:75], s16 offen offset:2048 sc1
    buffer_load_dwordx4 v[108:111], v244, s[72:75], s16 offen offset:3072 sc1
    s_waitcnt vmcnt(27) lgkmcnt(0)
    v_mfma_f32_32x32x16_bf16 v[16:31], v[192:195], v[64:67], 0
    ds_read_b64_tr_b16 v[208:209], v2 offset:12288
    ds_read_b64_tr_b16 v[210:211], v2 offset:13824
    s_add_u32 s16, s16, 4096
    buffer_load_dwordx4 v[112:115], v244, s[72:75], s16 offen offset:0 sc1
    v_mfma_f32_32x32x16_bf16 v[32:47], v[196:199], v[64:67], 0
    ds_read_b64_tr_b16 v[212:213], v2 offset:12352
    ds_read_b64_tr_b16 v[214:215], v2 offset:13888
    s_waitcnt vmcnt(27) lgkmcnt(4)
    v_mfma_f32_32x32x16_bf16 v[16:31], v[200:203], v[68:71], v[16:31]
    ds_read_b64_tr_b16 v[192:193], v2 offset:15360
    ds_read_b64_tr_b16 v[194:195], v2 offset:16896
    buffer_load_dwordx4 v[116:119], v244, s[72:75], s16 offen offset:1024 sc1
    v_mfma_f32_32x32x16_bf16 v[32:47], v[204:207], v[68:71], v[32:47]
    ds_read_b64_tr_b16 v[196:197], v2 offset:15424
    ds_read_b64_tr_b16 v[198:199], v2 offset:16960
    s_waitcnt vmcnt(27) lgkmcnt(4)
    v_mfma_f32_32x32x16_bf16 v[16:31], v[208:211], v[72:75], v[16:31]
    ds_read_b64_tr_b16 v[200:201], v2 offset:18432
    ds_read_b64_tr_b16 v[202:203], v2 offset:19968
    buffer_load_dwordx4 v[120:123], v244, s[72:75], s16 offen offset:2048 sc1
    v_mfma_f32_32x32x16_bf16 v[32:47], v[212:215], v[72:75], v[32:47]
    ds_read_b64_tr_b16 v[204:205], v2 offset:18496
    ds_read_b64_tr_b16 v[206:207], v2 offset:20032
    s_waitcnt vmcnt(27) lgkmcnt(4)
    v_mfma_f32_32x32x16_bf16 v[16:31], v[192:195], v[76:79], v[16:31]
    ds_read_b64_tr_b16 v[208:209], v2 offset:21504
    ds_read_b64_tr_b16 v[210:211], v2 offset:23040
    buffer_load_dwordx4 v[124:127], v244, s[72:75], s16 offen offset:3072 sc1
    v_mfma_f32_32x32x16_bf16 v[32:47], v[196:199], v[76:79], v[32:47]
    ds_read_b64_tr_b16 v[212:213], v2 offset:21568
    ds_read_b64_tr_b16 v[214:215], v2 offset:23104
    s_waitcnt vmcnt(11) lgkmcnt(4)
    v_mfma_f32_32x32x16_bf16 v[16:31], v[200:203], v[80:83], v[16:31]
    ds_read_b64_tr_b16 v[192:193], v2 offset:24576
    ds_read_b64_tr_b16 v[194:195], v2 offset:26112
    s_add_u32 s16, s16, 4096
    buffer_load_dwordx4 v[128:131], v244, s[72:75], s16 offen offset:0 sc1
    v_mfma_f32_32x32x16_bf16 v[32:47], v[204:207], v[80:83], v[32:47]
    ds_read_b64_tr_b16 v[196:197], v2 offset:24640
    ds_read_b64_tr_b16 v[198:199], v2 offset:26176
    s_waitcnt vmcnt(11) lgkmcnt(4)
    v_mfma_f32_32x32x16_bf16 v[16:31], v[208:211], v[84:87], v[16:31]
    ds_read_b64_tr_b16 v[200:201], v2 offset:27648
    ds_read_b64_tr_b16 v[202:203], v2 offset:29184
    buffer_load_dwordx4 v[132:135], v244, s[72:75], s16 offen offset:1024 sc1
    v_mfma_f32_32x32x16_bf16 v[32:47], v[212:215], v[84:87], v[32:47]
    ds_read_b64_tr_b16 v[204:205], v2 offset:27712
    ds_read_b64_tr_b16 v[206:207], v2 offset:29248
    v_add_f32 v216, v216, v224
    s_waitcnt vmcnt(11) lgkmcnt(4)
    v_mfma_f32_32x32x16_bf16 v[16:31], v[192:195], v[88:91], v[16:31]
    ds_read_b64_tr_b16 v[208:209], v2 offset:30720
    ds_read_b64_tr_b16 v[210:211], v2 offset:32256
    buffer_load_dwordx4 v[136:139], v244, s[72:75], s16 offen offset:2048 sc1
    v_mfma_f32_32x32x16_bf16 v[32:47], v[196:199], v[88:91], v[32:47]
    ds_read_b64_tr_b16 v[212:213], v2 offset:30784
    ds_read_b64_tr_b16 v[214:215], v2 offset:32320
    v_add_f32 v217, v217, v225
    s_waitcnt vmcnt(11) lgkmcnt(4)
    v_mfma_f32_32x32x16_bf16 v[16:31], v[200:203], v[92:95], v[16:31]
    ds_read_b64_tr_b16 v[192:193], v2 offset:33792
    ds_read_b64_tr_b16 v[194:195], v2 offset:35328
    buffer_load_dwordx4 v[140:143], v244, s[72:75], s16 offen offset:3072 sc1
    v_mfma_f32_32x32x16_bf16 v[32:47], v[204:207], v[92:95], v[32:47]
    ds_read_b64_tr_b16 v[196:197], v2 offset:33856
    ds_read_b64_tr_b16 v[198:199], v2 offset:35392
    v_add_f32 v218, v218, v226
    s_waitcnt vmcnt(11) lgkmcnt(4)
    v_mfma_f32_32x32x16_bf16 v[16:31], v[208:211], v[96:99], v[16:31]
    ds_read_b64_tr_b16 v[200:201], v2 offset:36864
    ds_read_b64_tr_b16 v[202:203], v2 offset:38400
    s_add_u32 s16, s16, 4096
    buffer_load_dwordx4 v[144:147], v244, s[72:75], s16 offen offset:0 sc1
    v_mfma_f32_32x32x16_bf16 v[32:47], v[212:215], v[96:99], v[32:47]
    ds_read_b64_tr_b16 v[204:205], v2 offset:36928
    ds_read_b64_tr_b16 v[206:207], v2 offset:38464
    v_add_f32 v219, v219, v227
    s_waitcnt vmcnt(11) lgkmcnt(4)
    v_mfma_f32_32x32x16_bf16 v[16:31], v[192:195], v[100:103], v[16:31]
    ds_read_b64_tr_b16 v[208:209], v2 offset:39936
    ds_read_b64_tr_b16 v[210:211], v2 offset:41472
    buffer_load_dwordx4 v[148:151], v244, s[72:75], s16 offen offset:1024 sc1
    v_mfma_f32_32x32x16_bf16 v[32:47], v[196:199], v[100:103], v[32:47]
    ds_read_b64_tr_b16 v[212:213], v2 offset:40000
    ds_read_b64_tr_b16 v[214:215], v2 offset:41536
    v_add_f32 v220, v220, v228
    s_waitcnt vmcnt(11) lgkmcnt(4)
    s_barrier
    v_mfma_f32_32x32x16_bf16 v[16:31], v[200:203], v[104:107], v[16:31]
    ds_read_b64_tr_b16 v[192:193], v2 offset:43008
    ds_read_b64_tr_b16 v[194:195], v2 offset:44544
    buffer_load_dwordx4 v[152:155], v244, s[72:75], s16 offen offset:2048 sc1
    v_mfma_f32_32x32x16_bf16 v[32:47], v[204:207], v[104:107], v[32:47]
    ds_read_b64_tr_b16 v[196:197], v2 offset:43072
    ds_read_b64_tr_b16 v[198:199], v2 offset:44608
    v_add_f32 v221, v221, v229
    s_waitcnt vmcnt(11) lgkmcnt(4)
    v_mfma_f32_32x32x16_bf16 v[16:31], v[208:211], v[108:111], v[16:31]
    ds_read_b64_tr_b16 v[200:201], v2 offset:46080
    ds_read_b64_tr_b16 v[202:203], v2 offset:47616
    buffer_load_dwordx4 v[156:159], v244, s[72:75], s16 offen offset:3072 sc1
    v_mfma_f32_32x32x16_bf16 v[32:47], v[212:215], v[108:111], v[32:47]
    ds_read_b64_tr_b16 v[204:205], v2 offset:46144
    ds_read_b64_tr_b16 v[206:207], v2 offset:47680
    v_add_f32 v222, v222, v230
    s_waitcnt vmcnt(11) lgkmcnt(4)
    v_mfma_f32_32x32x16_bf16 v[16:31], v[192:195], v[112:115], v[16:31]
    ds_read_b64_tr_b16 v[208:209], v3 offset:0
    ds_read_b64_tr_b16 v[210:211], v3 offset:1536
    s_add_u32 s16, s16, 4096
    buffer_load_dwordx4 v[160:163], v244, s[72:75], s16 offen offset:0 sc1
    v_mfma_f32_32x32x16_bf16 v[32:47], v[196:199], v[112:115], v[32:47]
    ds_read_b64_tr_b16 v[212:213], v3 offset:64
    ds_read_b64_tr_b16 v[214:215], v3 offset:1600
    v_add_f32 v223, v223, v231
    s_waitcnt vmcnt(11) lgkmcnt(4)
    v_mfma_f32_32x32x16_bf16 v[16:31], v[200:203], v[116:119], v[16:31]
    ds_read_b64_tr_b16 v[192:193], v3 offset:3072
    ds_read_b64_tr_b16 v[194:195], v3 offset:4608
    buffer_load_dwordx4 v[164:167], v244, s[72:75], s16 offen offset:1024 sc1
    v_mfma_f32_32x32x16_bf16 v[32:47], v[204:207], v[116:119], v[32:47]
    ds_read_b64_tr_b16 v[196:197], v3 offset:3136
    ds_read_b64_tr_b16 v[198:199], v3 offset:4672
    v_add_f32 v216, v216, v220
    s_waitcnt vmcnt(11) lgkmcnt(4)
    v_mfma_f32_32x32x16_bf16 v[16:31], v[208:211], v[120:123], v[16:31]
    ds_read_b64_tr_b16 v[200:201], v3 offset:6144
    ds_read_b64_tr_b16 v[202:203], v3 offset:7680
    buffer_load_dwordx4 v[168:171], v244, s[72:75], s16 offen offset:2048 sc1
    v_mfma_f32_32x32x16_bf16 v[32:47], v[212:215], v[120:123], v[32:47]
    ds_read_b64_tr_b16 v[204:205], v3 offset:6208
    ds_read_b64_tr_b16 v[206:207], v3 offset:7744
    v_add_f32 v217, v217, v221
    s_waitcnt vmcnt(11) lgkmcnt(4)
    v_mfma_f32_32x32x16_bf16 v[16:31], v[192:195], v[124:127], v[16:31]
    ds_read_b64_tr_b16 v[208:209], v3 offset:9216
    ds_read_b64_tr_b16 v[210:211], v3 offset:10752
    buffer_load_dwordx4 v[172:175], v244, s[72:75], s16 offen offset:3072 sc1
    v_mfma_f32_32x32x16_bf16 v[32:47], v[196:199], v[124:127], v[32:47]
    ds_read_b64_tr_b16 v[212:213], v3 offset:9280
    ds_read_b64_tr_b16 v[214:215], v3 offset:10816
    v_add_f32 v218, v218, v222
    s_waitcnt vmcnt(11) lgkmcnt(4)
    v_mfma_f32_32x32x16_bf16 v[16:31], v[200:203], v[128:131], v[16:31]
    ds_read_b64_tr_b16 v[192:193], v3 offset:12288
    ds_read_b64_tr_b16 v[194:195], v3 offset:13824
    s_add_u32 s16, s16, 4096
    buffer_load_dwordx4 v[176:179], v244, s[72:75], s16 offen offset:0 sc1
    v_mfma_f32_32x32x16_bf16 v[32:47], v[204:207], v[128:131], v[32:47]
    ds_read_b64_tr_b16 v[196:197], v3 offset:12352
    ds_read_b64_tr_b16 v[198:199], v3 offset:13888
    v_add_f32 v219, v219, v223
    s_waitcnt vmcnt(11) lgkmcnt(4)
    v_mfma_f32_32x32x16_bf16 v[16:31], v[208:211], v[132:135], v[16:31]
    ds_read_b64_tr_b16 v[200:201], v3 offset:15360
    ds_read_b64_tr_b16 v[202:203], v3 offset:16896
    buffer_load_dwordx4 v[180:183], v244, s[72:75], s16 offen offset:1024 sc1
    v_mfma_f32_32x32x16_bf16 v[32:47], v[212:215], v[132:135], v[32:47]
    ds_read_b64_tr_b16 v[204:205], v3 offset:15424
    ds_read_b64_tr_b16 v[206:207], v3 offset:16960
    v_add_f32 v216, v216, v218
    s_waitcnt vmcnt(11) lgkmcnt(4)
    v_mfma_f32_32x32x16_bf16 v[16:31], v[192:195], v[136:139], v[16:31]
    ds_read_b64_tr_b16 v[208:209], v3 offset:18432
    ds_read_b64_tr_b16 v[210:211], v3 offset:19968
    buffer_load_dwordx4 v[184:187], v244, s[72:75], s16 offen offset:2048 sc1
    v_mfma_f32_32x32x16_bf16 v[32:47], v[196:199], v[136:139], v[32:47]
    ds_read_b64_tr_b16 v[212:213], v3 offset:18496
    ds_read_b64_tr_b16 v[214:215], v3 offset:20032
    v_add_f32 v217, v217, v219
    s_waitcnt vmcnt(11) lgkmcnt(4)
    v_mfma_f32_32x32x16_bf16 v[16:31], v[200:203], v[140:143], v[16:31]
    ds_read_b64_tr_b16 v[192:193], v3 offset:21504
    ds_read_b64_tr_b16 v[194:195], v3 offset:23040
    buffer_load_dwordx4 v[188:191], v244, s[72:75], s16 offen offset:3072 sc1
    s_barrier
    v_mfma_f32_32x32x16_bf16 v[32:47], v[204:207], v[140:143], v[32:47]
    ds_read_b64_tr_b16 v[196:197], v3 offset:21568
    ds_read_b64_tr_b16 v[198:199], v3 offset:23104
    v_add_f32 v216, v216, v217
    s_waitcnt vmcnt(11) lgkmcnt(4)
    v_mfma_f32_32x32x16_bf16 v[16:31], v[208:211], v[144:147], v[16:31]
    ds_read_b64_tr_b16 v[200:201], v3 offset:24576
    ds_read_b64_tr_b16 v[202:203], v3 offset:26112
    v_mov_b32 v217, v216
    s_nop 1
    v_permlane32_swap_b32 v216, v217
    v_mfma_f32_32x32x16_bf16 v[32:47], v[212:215], v[144:147], v[32:47]
    ds_read_b64_tr_b16 v[204:205], v3 offset:24640
    ds_read_b64_tr_b16 v[206:207], v3 offset:26176
    v_mul_f32 v216, 0x3b000000, v216
    s_waitcnt vmcnt(10) lgkmcnt(4)
    v_mfma_f32_32x32x16_bf16 v[16:31], v[192:195], v[148:151], v[16:31]
    ds_read_b64_tr_b16 v[208:209], v3 offset:27648
    ds_read_b64_tr_b16 v[210:211], v3 offset:29184
    v_mul_f32 v217, 0x3b000000, v217
    v_fma_f32 v217, -v216, v216, v217
    v_mfma_f32_32x32x16_bf16 v[32:47], v[196:199], v[148:151], v[32:47]
    ds_read_b64_tr_b16 v[212:213], v3 offset:27712
    ds_read_b64_tr_b16 v[214:215], v3 offset:29248
    v_max_f32 v217, 0, v217
    s_waitcnt vmcnt(9) lgkmcnt(4)
    v_mfma_f32_32x32x16_bf16 v[16:31], v[200:203], v[152:155], v[16:31]
    ds_read_b64_tr_b16 v[192:193], v3 offset:30720
    ds_read_b64_tr_b16 v[194:195], v3 offset:32256
    v_add_f32 v217, 0x3727c5ac, v217
    v_rsq_f32 v14, v217
    v_mfma_f32_32x32x16_bf16 v[32:47], v[204:207], v[152:155], v[32:47]
    ds_read_b64_tr_b16 v[196:197], v3 offset:30784
    ds_read_b64_tr_b16 v[198:199], v3 offset:32320
    v_sqrt_f32 v217, v217
    s_waitcnt vmcnt(8) lgkmcnt(4)
    v_mfma_f32_32x32x16_bf16 v[16:31], v[208:211], v[156:159], v[16:31]
    ds_read_b64_tr_b16 v[200:201], v3 offset:33792
    ds_read_b64_tr_b16 v[202:203], v3 offset:35328
    v_mov_b32 v11, 0
    v_cvt_pk_bf16_f32 v12, v217, v216
    v_mfma_f32_32x32x16_bf16 v[32:47], v[212:215], v[156:159], v[32:47]
    ds_read_b64_tr_b16 v[204:205], v3 offset:33856
    ds_read_b64_tr_b16 v[206:207], v3 offset:35392
    v_lshlrev_b32 v218, 16, v12
    s_waitcnt vmcnt(7) lgkmcnt(4)
    v_mfma_f32_32x32x16_bf16 v[16:31], v[192:195], v[160:163], v[16:31]
    ds_read_b64_tr_b16 v[208:209], v3 offset:36864
    ds_read_b64_tr_b16 v[210:211], v3 offset:38400
    v_and_b32 v219, 0xffff0000, v12
    v_sub_f32 v218, v217, v218
    v_mfma_f32_32x32x16_bf16 v[32:47], v[196:199], v[160:163], v[32:47]
    ds_read_b64_tr_b16 v[212:213], v3 offset:36928
    ds_read_b64_tr_b16 v[214:215], v3 offset:38464
    v_sub_f32 v219, v216, v219
    s_waitcnt vmcnt(6) lgkmcnt(4)
    v_mfma_f32_32x32x16_bf16 v[16:31], v[200:203], v[164:167], v[16:31]
    ds_read_b64_tr_b16 v[192:193], v3 offset:39936
    ds_read_b64_tr_b16 v[194:195], v3 offset:41472
    v_cvt_pk_bf16_f32 v13, v218, v219
    v_and_b32 v8, 0xffff, v12
    v_mfma_f32_32x32x16_bf16 v[32:47], v[204:207], v[164:167], v[32:47]
    ds_read_b64_tr_b16 v[196:197], v3 offset:40000
    ds_read_b64_tr_b16 v[198:199], v3 offset:41536
    v_lshrrev_b32 v10, 16, v12
    s_waitcnt vmcnt(5) lgkmcnt(4)
    v_mfma_f32_32x32x16_bf16 v[16:31], v[208:211], v[168:171], v[16:31]
    ds_read_b64_tr_b16 v[200:201], v3 offset:43008
    ds_read_b64_tr_b16 v[202:203], v3 offset:44544
    v_lshl_or_b32 v8, v13, 16, v8
    v_and_b32 v13, 0xffff0000, v13
    v_mfma_f32_32x32x16_bf16 v[32:47], v[212:215], v[168:171], v[32:47]
    ds_read_b64_tr_b16 v[204:205], v3 offset:43072
    ds_read_b64_tr_b16 v[206:207], v3 offset:44608
    v_or_b32 v9, v10, v13
    s_waitcnt vmcnt(4) lgkmcnt(4)
    v_mfma_f32_32x32x16_bf16 v[16:31], v[192:195], v[172:175], v[16:31]
    ds_read_b64_tr_b16 v[208:209], v3 offset:46080
    ds_read_b64_tr_b16 v[210:211], v3 offset:47616
    v_mfma_f32_32x32x16_bf16 v[32:47], v[196:199], v[172:175], v[32:47]
    ds_read_b64_tr_b16 v[212:213], v3 offset:46144
    ds_read_b64_tr_b16 v[214:215], v3 offset:47680
    s_mov_b32 exec_hi, 0
    ds_read_b128 v[232:235], v4 offset:0
    ds_read_b128 v[236:239], v4 offset:512
    ds_read_b128 v[240:243], v4 offset:1024
    s_mov_b32 exec_hi, -1
    s_waitcnt vmcnt(3) lgkmcnt(4)
    v_mfma_f32_32x32x16_bf16 v[16:31], v[200:203], v[176:179], v[16:31]
    ds_read_b64_tr_b16 v[192:193], v2 offset:0
    ds_read_b64_tr_b16 v[194:195], v2 offset:1536
    v_mfma_f32_32x32x16_bf16 v[32:47], v[204:207], v[176:179], v[32:47]
    ds_read_b64_tr_b16 v[196:197], v2 offset:64
    ds_read_b64_tr_b16 v[198:199], v2 offset:1600
    s_waitcnt vmcnt(2) lgkmcnt(4)
    v_mfma_f32_32x32x16_bf16 v[16:31], v[208:211], v[180:183], v[16:31]
    ds_read_b64_tr_b16 v[200:201], v2 offset:3072
    ds_read_b64_tr_b16 v[202:203], v2 offset:4608
    v_mfma_f32_32x32x16_bf16 v[32:47], v[212:215], v[180:183], v[32:47]
    ds_read_b64_tr_b16 v[204:205], v2 offset:3136
    ds_read_b64_tr_b16 v[206:207], v2 offset:4672
    s_waitcnt vmcnt(1) lgkmcnt(4)
    v_mfma_f32_32x32x16_bf16 v[16:31], v[192:195], v[184:187], v[16:31]
    ds_read_b64_tr_b16 v[216:217], v2 offset:6272
    ds_read_b64_tr_b16 v[218:219], v2 offset:7808
    v_mfma_f32_32x32x16_bf16 v[32:47], v[196:199], v[184:187], v[32:47]
    ds_read_b64_tr_b16 v[220:221], v2 offset:9344
    ds_read_b64_tr_b16 v[222:223], v2 offset:10880
    s_waitcnt vmcnt(0) lgkmcnt(4)
    v_mfma_f32_32x32x16_bf16 v[16:31], v[200:203], v[188:191], v[16:31]
    ds_read_b64_tr_b16 v[224:225], v2 offset:12416
    ds_read_b64_tr_b16 v[226:227], v2 offset:13952
    v_mfma_f32_32x32x16_bf16 v[32:47], v[204:207], v[188:191], v[32:47]
    ds_read_b64_tr_b16 v[228:229], v2 offset:15488
    ds_read_b64_tr_b16 v[230:231], v2 offset:17024
    v_mfma_f32_32x32x16_bf16 v[16:31], v[232:235], v[8:11], v[16:31]
    v_mfma_f32_32x32x16_bf16 v[32:47], v[236:239], v[8:11], v[32:47]
    v_mfma_f32_32x32x16_bf16 v[48:63], v[240:243], v[8:11], 0
    s_waitcnt lgkmcnt(6)
    v_mfma_f32_32x32x16_bf16 v[48:63], v[216:219], v[64:67], v[48:63]
    ds_read_b64_tr_b16 v[216:217], v2 offset:18560
    ds_read_b64_tr_b16 v[218:219], v2 offset:20096
    s_waitcnt lgkmcnt(6)
    v_mfma_f32_32x32x16_bf16 v[48:63], v[220:223], v[68:71], v[48:63]
    ds_read_b64_tr_b16 v[220:221], v2 offset:21632
    ds_read_b64_tr_b16 v[222:223], v2 offset:23168
    s_nop 1
    v_max_f32 v16, 0, v16
    v_max_f32 v17, 0, v17
    v_mul_f32 v16, v14, v16
    v_mul_f32 v17, v14, v17
    s_waitcnt lgkmcnt(6)
    v_mfma_f32_32x32x16_bf16 v[48:63], v[224:227], v[72:75], v[48:63]
    ds_read_b64_tr_b16 v[224:225], v2 offset:24704
    ds_read_b64_tr_b16 v[226:227], v2 offset:26240
    v_mul_f32 v16, v16, v16
    v_mul_f32 v17, v17, v17
    v_cvt_pk_bf16_f32 v192, v16, v17
    v_max_f32 v18, 0, v18
    s_waitcnt lgkmcnt(6)
    v_mfma_f32_32x32x16_bf16 v[48:63], v[228:231], v[76:79], v[48:63]
    ds_read_b64_tr_b16 v[228:229], v2 offset:27776
    ds_read_b64_tr_b16 v[230:231], v2 offset:29312
    v_max_f32 v19, 0, v19
    v_mul_f32 v18, v14, v18
    v_mul_f32 v19, v14, v19
    v_mul_f32 v18, v18, v18
    s_waitcnt lgkmcnt(6)
    v_mfma_f32_32x32x16_bf16 v[48:63], v[216:219], v[80:83], v[48:63]
    ds_read_b64_tr_b16 v[216:217], v2 offset:30848
    ds_read_b64_tr_b16 v[218:219], v2 offset:32384
    v_mul_f32 v19, v19, v19
    v_cvt_pk_bf16_f32 v193, v18, v19
    v_max_f32 v20, 0, v20
    v_max_f32 v21, 0, v21
    s_waitcnt lgkmcnt(6)
    v_mfma_f32_32x32x16_bf16 v[48:63], v[220:223], v[84:87], v[48:63]
    ds_read_b64_tr_b16 v[220:221], v2 offset:33920
    ds_read_b64_tr_b16 v[222:223], v2 offset:35456
    v_mul_f32 v20, v14, v20
    v_mul_f32 v21, v14, v21
    v_mul_f32 v20, v20, v20
    v_mul_f32 v21, v21, v21
    s_waitcnt lgkmcnt(6)
    v_mfma_f32_32x32x16_bf16 v[48:63], v[224:227], v[88:91], v[48:63]
    ds_read_b64_tr_b16 v[224:225], v2 offset:36992
    ds_read_b64_tr_b16 v[226:227], v2 offset:38528
    v_cvt_pk_bf16_f32 v194, v20, v21
    v_max_f32 v22, 0, v22
    v_max_f32 v23, 0, v23
    v_mul_f32 v22, v14, v22
    s_waitcnt lgkmcnt(6)
    v_mfma_f32_32x32x16_bf16 v[48:63], v[228:231], v[92:95], v[48:63]
    ds_read_b64_tr_b16 v[228:229], v2 offset:40064
    ds_read_b64_tr_b16 v[230:231], v2 offset:41600
    v_mul_f32 v23, v14, v23
    v_mul_f32 v22, v22, v22
    v_mul_f32 v23, v23, v23
    v_cvt_pk_bf16_f32 v195, v22, v23
    s_waitcnt lgkmcnt(6)
    v_mfma_f32_32x32x16_bf16 v[48:63], v[216:219], v[96:99], v[48:63]
    ds_read_b64_tr_b16 v[216:217], v2 offset:43136
    ds_read_b64_tr_b16 v[218:219], v2 offset:44672
    v_max_f32 v24, 0, v24
    v_max_f32 v25, 0, v25
    v_mul_f32 v24, v14, v24
    v_mul_f32 v25, v14, v25
    s_waitcnt lgkmcnt(6)
    v_mfma_f32_32x32x16_bf16 v[48:63], v[220:223], v[100:103], v[48:63]
    ds_read_b64_tr_b16 v[220:221], v2 offset:46208
    ds_read_b64_tr_b16 v[222:223], v2 offset:47744
    v_mul_f32 v24, v24, v24
    v_mul_f32 v25, v25, v25
    v_cvt_pk_bf16_f32 v196, v24, v25
    v_max_f32 v26, 0, v26
    s_waitcnt lgkmcnt(6)
    v_mfma_f32_32x32x16_bf16 v[48:63], v[224:227], v[104:107], v[48:63]
    ds_read_b64_tr_b16 v[224:225], v3 offset:128
    ds_read_b64_tr_b16 v[226:227], v3 offset:1664
    v_max_f32 v27, 0, v27
    v_mul_f32 v26, v14, v26
    v_mul_f32 v27, v14, v27
    v_mul_f32 v26, v26, v26
    s_waitcnt lgkmcnt(6)
    v_mfma_f32_32x32x16_bf16 v[48:63], v[228:231], v[108:111], v[48:63]
    ds_read_b64_tr_b16 v[228:229], v3 offset:3200
    ds_read_b64_tr_b16 v[230:231], v3 offset:4736
    v_mul_f32 v27, v27, v27
    v_cvt_pk_bf16_f32 v197, v26, v27
    v_max_f32 v28, 0, v28
    v_max_f32 v29, 0, v29
    s_waitcnt lgkmcnt(6)
    v_mfma_f32_32x32x16_bf16 v[48:63], v[216:219], v[112:115], v[48:63]
    ds_read_b64_tr_b16 v[216:217], v3 offset:6272
    ds_read_b64_tr_b16 v[218:219], v3 offset:7808
    v_mul_f32 v28, v14, v28
    v_mul_f32 v29, v14, v29
    v_mul_f32 v28, v28, v28
    v_mul_f32 v29, v29, v29
    s_waitcnt lgkmcnt(6)
    v_mfma_f32_32x32x16_bf16 v[48:63], v[220:223], v[116:119], v[48:63]
    ds_read_b64_tr_b16 v[220:221], v3 offset:9344
    ds_read_b64_tr_b16 v[222:223], v3 offset:10880
    v_cvt_pk_bf16_f32 v198, v28, v29
    v_max_f32 v30, 0, v30
    v_max_f32 v31, 0, v31
    v_mul_f32 v30, v14, v30
    s_waitcnt lgkmcnt(6)
    v_mfma_f32_32x32x16_bf16 v[48:63], v[224:227], v[120:123], v[48:63]
    ds_read_b64_tr_b16 v[224:225], v3 offset:12416
    ds_read_b64_tr_b16 v[226:227], v3 offset:13952
    v_mul_f32 v31, v14, v31
    v_mul_f32 v30, v30, v30
    v_mul_f32 v31, v31, v31
    v_cvt_pk_bf16_f32 v199, v30, v31
    s_waitcnt lgkmcnt(6)
    v_mfma_f32_32x32x16_bf16 v[48:63], v[228:231], v[124:127], v[48:63]
    ds_read_b64_tr_b16 v[228:229], v3 offset:15488
    ds_read_b64_tr_b16 v[230:231], v3 offset:17024
    buffer_store_dwordx4 v[192:195], v244, s[72:75], s17 offen offset:0 sc1
    buffer_store_dwordx4 v[196:199], v244, s[72:75], s17 offen offset:1024 sc1
    v_max_f32 v32, 0, v32
    v_max_f32 v33, 0, v33
    v_mul_f32 v32, v14, v32
    s_waitcnt lgkmcnt(6)
    v_mfma_f32_32x32x16_bf16 v[48:63], v[216:219], v[128:131], v[48:63]
    ds_read_b64_tr_b16 v[216:217], v3 offset:18560
    ds_read_b64_tr_b16 v[218:219], v3 offset:20096
    v_mul_f32 v33, v14, v33
    v_mul_f32 v32, v32, v32
    v_mul_f32 v33, v33, v33
    v_cvt_pk_bf16_f32 v200, v32, v33
    s_waitcnt lgkmcnt(6)
    v_mfma_f32_32x32x16_bf16 v[48:63], v[220:223], v[132:135], v[48:63]
    ds_read_b64_tr_b16 v[220:221], v3 offset:21632
    ds_read_b64_tr_b16 v[222:223], v3 offset:23168
    v_max_f32 v34, 0, v34
    v_max_f32 v35, 0, v35
    v_mul_f32 v34, v14, v34
    v_mul_f32 v35, v14, v35
    s_waitcnt lgkmcnt(6)
    v_mfma_f32_32x32x16_bf16 v[48:63], v[224:227], v[136:139], v[48:63]
    ds_read_b64_tr_b16 v[224:225], v3 offset:24704
    ds_read_b64_tr_b16 v[226:227], v3 offset:26240
    v_mul_f32 v34, v34, v34
    v_mul_f32 v35, v35, v35
    v_cvt_pk_bf16_f32 v201, v34, v35
    v_max_f32 v36, 0, v36
    s_waitcnt lgkmcnt(6)
    v_mfma_f32_32x32x16_bf16 v[48:63], v[228:231], v[140:143], v[48:63]
    ds_read_b64_tr_b16 v[228:229], v3 offset:27776
    ds_read_b64_tr_b16 v[230:231], v3 offset:29312
    v_max_f32 v37, 0, v37
    v_mul_f32 v36, v14, v36
    v_mul_f32 v37, v14, v37
    v_mul_f32 v36, v36, v36
    s_waitcnt lgkmcnt(6)
    v_mfma_f32_32x32x16_bf16 v[48:63], v[216:219], v[144:147], v[48:63]
    ds_read_b64_tr_b16 v[216:217], v3 offset:30848
    ds_read_b64_tr_b16 v[218:219], v3 offset:32384
    v_mul_f32 v37, v37, v37
    v_cvt_pk_bf16_f32 v202, v36, v37
    v_max_f32 v38, 0, v38
    v_max_f32 v39, 0, v39
    s_waitcnt lgkmcnt(6)
    v_mfma_f32_32x32x16_bf16 v[48:63], v[220:223], v[148:151], v[48:63]
    ds_read_b64_tr_b16 v[220:221], v3 offset:33920
    ds_read_b64_tr_b16 v[222:223], v3 offset:35456
    v_mul_f32 v38, v14, v38
    v_mul_f32 v39, v14, v39
    v_mul_f32 v38, v38, v38
    v_mul_f32 v39, v39, v39
    s_waitcnt lgkmcnt(6)
    v_mfma_f32_32x32x16_bf16 v[48:63], v[224:227], v[152:155], v[48:63]
    ds_read_b64_tr_b16 v[224:225], v3 offset:36992
    ds_read_b64_tr_b16 v[226:227], v3 offset:38528
    v_cvt_pk_bf16_f32 v203, v38, v39
    v_max_f32 v40, 0, v40
    v_max_f32 v41, 0, v41
    v_mul_f32 v40, v14, v40
    s_waitcnt lgkmcnt(6)
    v_mfma_f32_32x32x16_bf16 v[48:63], v[228:231], v[156:159], v[48:63]
    ds_read_b64_tr_b16 v[228:229], v3 offset:40064
    ds_read_b64_tr_b16 v[230:231], v3 offset:41600
    v_mul_f32 v41, v14, v41
    v_mul_f32 v40, v40, v40
    v_mul_f32 v41, v41, v41
    v_cvt_pk_bf16_f32 v204, v40, v41
    s_waitcnt lgkmcnt(6)
    v_mfma_f32_32x32x16_bf16 v[48:63], v[216:219], v[160:163], v[48:63]
    ds_read_b64_tr_b16 v[216:217], v3 offset:43136
    ds_read_b64_tr_b16 v[218:219], v3 offset:44672
    v_max_f32 v42, 0, v42
    v_max_f32 v43, 0, v43
    v_mul_f32 v42, v14, v42
    v_mul_f32 v43, v14, v43
    s_waitcnt lgkmcnt(6)
    v_mfma_f32_32x32x16_bf16 v[48:63], v[220:223], v[164:167], v[48:63]
    ds_read_b64_tr_b16 v[220:221], v3 offset:46208
    ds_read_b64_tr_b16 v[222:223], v3 offset:47744
    v_mul_f32 v42, v42, v42
    v_mul_f32 v43, v43, v43
    v_cvt_pk_bf16_f32 v205, v42, v43
    v_max_f32 v44, 0, v44
    s_waitcnt lgkmcnt(6)
    v_mfma_f32_32x32x16_bf16 v[48:63], v[224:227], v[168:171], v[48:63]
    ds_read_b64_tr_b16 v[224:225], v2 offset:128
    ds_read_b64_tr_b16 v[226:227], v2 offset:1664
    v_max_f32 v45, 0, v45
    v_mul_f32 v44, v14, v44
    v_mul_f32 v45, v14, v45
    v_mul_f32 v44, v44, v44
    s_waitcnt lgkmcnt(6)
    v_mfma_f32_32x32x16_bf16 v[48:63], v[228:231], v[172:175], v[48:63]
    ds_read_b64_tr_b16 v[228:229], v2 offset:3200
    ds_read_b64_tr_b16 v[230:231], v2 offset:4736
    v_mul_f32 v45, v45, v45
    v_cvt_pk_bf16_f32 v206, v44, v45
    v_max_f32 v46, 0, v46
    v_max_f32 v47, 0, v47
    s_waitcnt lgkmcnt(6)
    v_mfma_f32_32x32x16_bf16 v[48:63], v[216:219], v[176:179], v[48:63]
    v_mul_f32 v46, v14, v46
    v_mul_f32 v47, v14, v47
    v_mul_f32 v46, v46, v46
    v_mul_f32 v47, v47, v47
    s_waitcnt lgkmcnt(4)
    v_mfma_f32_32x32x16_bf16 v[48:63], v[220:223], v[180:183], v[48:63]
    v_cvt_pk_bf16_f32 v207, v46, v47
    s_cmp_eq_u32 s7, 14
    s_cbranch_scc1 L65
    buffer_store_dwordx4 v[200:203], v244, s[72:75], s17 offen offset:2048 sc1
    buffer_store_dwordx4 v[204:207], v244, s[72:75], s17 offen offset:3072 sc1
L65:
    s_waitcnt lgkmcnt(2)
    v_mfma_f32_32x32x16_bf16 v[48:63], v[224:227], v[184:187], v[48:63]
    s_waitcnt lgkmcnt(0)
    v_mfma_f32_32x32x16_bf16 v[48:63], v[228:231], v[188:191], v[48:63]
    s_barrier
    s_nop 10
    v_max_f32 v48, 0, v48
    v_max_f32 v49, 0, v49
    v_max_f32 v50, 0, v50
    v_max_f32 v51, 0, v51
    v_max_f32 v52, 0, v52
    v_max_f32 v53, 0, v53
    v_max_f32 v54, 0, v54
    v_max_f32 v55, 0, v55
    v_max_f32 v56, 0, v56
    v_max_f32 v57, 0, v57
    v_max_f32 v58, 0, v58
    v_max_f32 v59, 0, v59
    v_max_f32 v60, 0, v60
    v_max_f32 v61, 0, v61
    v_max_f32 v62, 0, v62
    v_max_f32 v63, 0, v63
    v_pk_mul_f32 v[48:49], v[48:49], v[14:15] op_sel_hi:[1,0]
    v_pk_mul_f32 v[50:51], v[50:51], v[14:15] op_sel_hi:[1,0]
    v_pk_mul_f32 v[52:53], v[52:53], v[14:15] op_sel_hi:[1,0]
    v_pk_mul_f32 v[54:55], v[54:55], v[14:15] op_sel_hi:[1,0]
    v_pk_mul_f32 v[56:57], v[56:57], v[14:15] op_sel_hi:[1,0]
    v_pk_mul_f32 v[58:59], v[58:59], v[14:15] op_sel_hi:[1,0]
    v_pk_mul_f32 v[60:61], v[60:61], v[14:15] op_sel_hi:[1,0]
    v_pk_mul_f32 v[62:63], v[62:63], v[14:15] op_sel_hi:[1,0]
    v_pk_mul_f32 v[48:49], v[48:49], v[48:49]
    v_pk_mul_f32 v[50:51], v[50:51], v[50:51]
    v_pk_mul_f32 v[52:53], v[52:53], v[52:53]
    v_pk_mul_f32 v[54:55], v[54:55], v[54:55]
    v_pk_mul_f32 v[56:57], v[56:57], v[56:57]
    v_pk_mul_f32 v[58:59], v[58:59], v[58:59]
    v_pk_mul_f32 v[60:61], v[60:61], v[60:61]
    v_pk_mul_f32 v[62:63], v[62:63], v[62:63]
    v_cvt_pk_bf16_f32 v208, v48, v49
    v_cvt_pk_bf16_f32 v209, v50, v51
    v_cvt_pk_bf16_f32 v210, v52, v53
    v_cvt_pk_bf16_f32 v211, v54, v55
    v_cvt_pk_bf16_f32 v212, v56, v57
    v_cvt_pk_bf16_f32 v213, v58, v59
    v_cvt_pk_bf16_f32 v214, v60, v61
    v_cvt_pk_bf16_f32 v215, v62, v63
    s_cmp_eq_u32 s7, 14
    s_cbranch_scc1 L66
    buffer_store_dwordx4 v[208:211], v244, s[72:75], s19 offen offset:0 sc1
    buffer_store_dwordx4 v[212:215], v244, s[72:75], s19 offen offset:1024 sc1
L66:
    s_branch Ls5
Ls4skip:
    s_barrier
    s_barrier
    s_barrier
Ls5:
    v_lshrrev_b32 v4, 5, v0
    v_lshlrev_b32 v4, 4, v4
    s_lshl_b32 s13, s81, 7
    s_add_u32 s13, s13, 101632
    v_add_u32 v4, s13, v4
    ds_read_b128 v[16:19], v4 offset:0
    ds_read_b128 v[20:23], v4 offset:32
    ds_read_b128 v[24:27], v4 offset:64
    ds_read_b128 v[28:31], v4 offset:96
    s_lshl_b32 s13, s23, 4
    s_mul_i32 s14, s81, 7
    s_add_u32 s13, s13, s14
    v_add_u32 v5, s13, v0
    v_lshlrev_b32 v5, 7, v5
    v_add_u32 v5, 17301504, v5
    s_mul_i32 s16, s23, 86
    s_mul_i32 s13, s81, 43
    s_add_u32 s16, s16, s13
    s_lshl_b32 s16, s16, 10
    s_add_u32 s16, s16, 9437184
    v_lshrrev_b32 v2, 5, v0
    v_mul_u32_u24 v2, 4, v2
    v_bfe_u32 v4, v0, 2, 2
    v_add_u32 v2, v2, v4
    v_mul_u32_u24 v2, 128, v2
    v_bfe_u32 v4, v0, 3, 1
    v_xor_b32 v4, s81, v4
    v_lshl_add_u32 v2, v4, 6, v2
    v_bfe_u32 v4, v0, 4, 1
    v_lshl_add_u32 v2, v4, 5, v2
    v_and_b32 v4, 3, v0
    v_lshl_add_u32 v2, v4, 3, v2
    s_mul_i32 s13, s81, 49152
    s_add_u32 s13, s13, 0
    v_add_u32 v234, s13, v2
    v_xor_b32 v235, 64, v234
    s_mul_i32 s13, s81, 30720
    s_add_u32 s13, s13, 102400
    v_add_u32 v232, s13, v2
    v_xor_b32 v233, 64, v232
    s_lshl_b32 s14, s80, 12
    s_add_u32 s13, s13, s14
    s_add_u32 s13, s13, 8192
    v_add_u32 v236, s13, v244
    s_xor_b32 s15, s81, 1
    s_mul_i32 s13, s15, 30720
    s_add_u32 s13, s13, s14
    s_add_u32 s13, s13, 110592
    v_add_u32 v237, s13, v244
    s_waitcnt lgkmcnt(0)
    v_lshlrev_b32 v6, 16, v248
    v_and_b32 v7, 0xffff0000, v248
    v_add_f32 v16, v16, v6
    v_add_f32 v17, v17, v7
    v_lshlrev_b32 v6, 16, v249
    v_and_b32 v7, 0xffff0000, v249
    v_add_f32 v18, v18, v6
    v_add_f32 v19, v19, v7
    v_lshlrev_b32 v6, 16, v250
    v_and_b32 v7, 0xffff0000, v250
    v_add_f32 v20, v20, v6
    v_add_f32 v21, v21, v7
    v_lshlrev_b32 v6, 16, v251
    v_and_b32 v7, 0xffff0000, v251
    v_add_f32 v22, v22, v6
    v_add_f32 v23, v23, v7
    v_lshlrev_b32 v6, 16, v252
    v_and_b32 v7, 0xffff0000, v252
    v_add_f32 v24, v24, v6
    v_add_f32 v25, v25, v7
    v_lshlrev_b32 v6, 16, v253
    v_and_b32 v7, 0xffff0000, v253
    v_add_f32 v26, v26, v6
    v_add_f32 v27, v27, v7
    v_lshlrev_b32 v6, 16, v254
    v_and_b32 v7, 0xffff0000, v254
    v_add_f32 v28, v28, v6
    v_add_f32 v29, v29, v7
    v_lshlrev_b32 v6, 16, v255
    v_and_b32 v7, 0xffff0000, v255
    v_add_f32 v30, v30, v6
    v_add_f32 v31, v31, v7
    s_cmp_eq_u32 s7, 15
    s_cbranch_scc1 L67
    s_waitcnt vmcnt(0)
    s_lshl_b32 s9, s30, 7
    s_add_u32 s9, s9, 16777216
    v_mov_b32 v6, s9
    v_mov_b32 v7, 1
    s_mov_b64 exec, 1
    s_cmp_eq_u32 s83, 0
    s_cbranch_scc1 Lsl68
    buffer_store_dword v7, v6, s[72:75], 0 offen
    s_branch Lsd69
Lsl68:
    buffer_store_dword v7, v6, s[72:75], 0 offen sc1
Lsd69:
    s_mov_b64 exec, -1
L67:
    ds_read_b64_tr_b16 v[208:209], v232 offset:0
    ds_read_b64_tr_b16 v[210:211], v232 offset:1024
    ds_read_b64_tr_b16 v[212:213], v233 offset:0
    ds_read_b64_tr_b16 v[214:215], v233 offset:1024
    ds_read_b64_tr_b16 v[216:217], v232 offset:2048
    ds_read_b64_tr_b16 v[218:219], v232 offset:3072
    ds_read_b64_tr_b16 v[220:221], v233 offset:2048
    ds_read_b64_tr_b16 v[222:223], v233 offset:3072
    s_mov_b32 exec_lo, 0xff
    s_mov_b32 exec_hi, 0
    s_mov_b32 s8, 0
Lpoll70:
    buffer_load_dword v6, v5, s[72:75], 0 offen sc1
    s_add_u32 s8, s8, 1
    s_waitcnt vmcnt(0)
    v_cmp_eq_u32 vcc, 0, v6
    s_cmp_gt_u32 s8, 400000
    s_cbranch_scc1 Lpd71
    s_cbranch_vccnz Lpoll70
Lpd71:
    s_mov_b64 exec, -1
    buffer_load_dwordx4 v[48:51], v244, s[72:75], s16 offen offset:0 sc1
    buffer_load_dwordx4 v[52:55], v244, s[72:75], s16 offen offset:1024 sc1
    buffer_load_dwordx4 v[56:59], v244, s[72:75], s16 offen offset:2048 sc1
    buffer_load_dwordx4 v[60:63], v244, s[72:75], s16 offen offset:3072 sc1
    s_add_u32 s16, s16, 4096
    buffer_load_dwordx4 v[64:67], v244, s[72:75], s16 offen offset:0 sc1
    buffer_load_dwordx4 v[68:71], v244, s[72:75], s16 offen offset:1024 sc1
    buffer_load_dwordx4 v[72:75], v244, s[72:75], s16 offen offset:2048 sc1
    buffer_load_dwordx4 v[76:79], v244, s[72:75], s16 offen offset:3072 sc1
    s_add_u32 s16, s16, 4096
    buffer_load_dwordx4 v[80:83], v244, s[72:75], s16 offen offset:0 sc1
    buffer_load_dwordx4 v[84:87], v244, s[72:75], s16 offen offset:1024 sc1
    buffer_load_dwordx4 v[88:91], v244, s[72:75], s16 offen offset:2048 sc1
    buffer_load_dwordx4 v[92:95], v244, s[72:75], s16 offen offset:3072 sc1
    s_add_u32 s16, s16, 4096
    buffer_load_dwordx4 v[96:99], v244, s[72:75], s16 offen offset:0 sc1
    buffer_load_dwordx4 v[100:103], v244, s[72:75], s16 offen offset:1024 sc1
    buffer_load_dwordx4 v[104:107], v244, s[72:75], s16 offen offset:2048 sc1
    buffer_load_dwordx4 v[108:111], v244, s[72:75], s16 offen offset:3072 sc1
    v_and_b32 v4, 31, v0
    v_lshlrev_b32 v4, 10, v4
    v_lshrrev_b32 v5, 5, v0
    v_lshl_add_u32 v4, v5, 4, v4
    s_waitcnt vmcnt(15) lgkmcnt(4)
    v_mfma_f32_32x32x16_bf16 v[32:47], v[212:215], v[48:51], 0
    ds_read_b64_tr_b16 v[224:225], v232 offset:4096
    ds_read_b64_tr_b16 v[226:227], v232 offset:5120
    v_mfma_f32_32x32x16_bf16 v[16:31], v[208:211], v[48:51], v[16:31]
    ds_read_b64_tr_b16 v[228:229], v233 offset:4096
    ds_read_b64_tr_b16 v[230:231], v233 offset:5120
    s_add_u32 s16, s16, 4096
    buffer_load_dwordx4 v[112:115], v244, s[72:75], s16 offen offset:0 sc1
    s_waitcnt vmcnt(15) lgkmcnt(4)
    v_mfma_f32_32x32x16_bf16 v[32:47], v[220:223], v[52:55], v[32:47]
    ds_read_b64_tr_b16 v[208:209], v232 offset:6144
    ds_read_b64_tr_b16 v[210:211], v232 offset:7168
    v_mfma_f32_32x32x16_bf16 v[16:31], v[216:219], v[52:55], v[16:31]
    ds_read_b64_tr_b16 v[212:213], v233 offset:6144
    ds_read_b64_tr_b16 v[214:215], v233 offset:7168
    buffer_load_dwordx4 v[116:119], v244, s[72:75], s16 offen offset:1024 sc1
    s_waitcnt vmcnt(15) lgkmcnt(4)
    s_waitcnt lgkmcnt(0)
    s_barrier
    v_mfma_f32_32x32x16_bf16 v[32:47], v[228:231], v[56:59], v[32:47]
    ds_read_b64_tr_b16 v[216:217], v232 offset:8192
    ds_read_b64_tr_b16 v[218:219], v232 offset:9216
    v_mfma_f32_32x32x16_bf16 v[16:31], v[224:227], v[56:59], v[16:31]
    ds_read_b64_tr_b16 v[220:221], v233 offset:8192
    ds_read_b64_tr_b16 v[222:223], v233 offset:9216
    buffer_load_dwordx4 v[120:123], v244, s[72:75], s16 offen offset:2048 sc1
    s_waitcnt vmcnt(15) lgkmcnt(4)
    v_mfma_f32_32x32x16_bf16 v[32:47], v[212:215], v[60:63], v[32:47]
    ds_read_b64_tr_b16 v[224:225], v232 offset:10240
    ds_read_b64_tr_b16 v[226:227], v232 offset:11264
    v_mfma_f32_32x32x16_bf16 v[16:31], v[208:211], v[60:63], v[16:31]
    ds_read_b64_tr_b16 v[228:229], v233 offset:10240
    ds_read_b64_tr_b16 v[230:231], v233 offset:11264
    buffer_load_dwordx4 v[124:127], v244, s[72:75], s16 offen offset:3072 sc1
    s_waitcnt vmcnt(15) lgkmcnt(4)
    v_mfma_f32_32x32x16_bf16 v[32:47], v[220:223], v[64:67], v[32:47]
    ds_read_b64_tr_b16 v[208:209], v232 offset:12288
    ds_read_b64_tr_b16 v[210:211], v232 offset:13312
    v_mfma_f32_32x32x16_bf16 v[16:31], v[216:219], v[64:67], v[16:31]
    ds_read_b64_tr_b16 v[212:213], v233 offset:12288
    ds_read_b64_tr_b16 v[214:215], v233 offset:13312
    s_add_u32 s16, s16, 4096
    buffer_load_dwordx4 v[128:131], v244, s[72:75], s16 offen offset:0 sc1
    s_waitcnt vmcnt(15) lgkmcnt(4)
    v_mfma_f32_32x32x16_bf16 v[32:47], v[228:231], v[68:71], v[32:47]
    ds_read_b64_tr_b16 v[216:217], v232 offset:14336
    ds_read_b64_tr_b16 v[218:219], v232 offset:15360
    v_mfma_f32_32x32x16_bf16 v[16:31], v[224:227], v[68:71], v[16:31]
    ds_read_b64_tr_b16 v[220:221], v233 offset:14336
    ds_read_b64_tr_b16 v[222:223], v233 offset:15360
    buffer_load_dwordx4 v[132:135], v244, s[72:75], s16 offen offset:1024 sc1
    s_waitcnt vmcnt(15) lgkmcnt(4)
    v_mfma_f32_32x32x16_bf16 v[32:47], v[212:215], v[72:75], v[32:47]
    ds_read_b64_tr_b16 v[224:225], v232 offset:16384
    ds_read_b64_tr_b16 v[226:227], v232 offset:17408
    v_mfma_f32_32x32x16_bf16 v[16:31], v[208:211], v[72:75], v[16:31]
    ds_read_b64_tr_b16 v[228:229], v233 offset:16384
    ds_read_b64_tr_b16 v[230:231], v233 offset:17408
    buffer_load_dwordx4 v[136:139], v244, s[72:75], s16 offen offset:2048 sc1
    s_waitcnt vmcnt(15) lgkmcnt(4)
    v_mfma_f32_32x32x16_bf16 v[32:47], v[220:223], v[76:79], v[32:47]
    ds_read_b64_tr_b16 v[208:209], v232 offset:18432
    ds_read_b64_tr_b16 v[210:211], v232 offset:19456
    v_mfma_f32_32x32x16_bf16 v[16:31], v[216:219], v[76:79], v[16:31]
    ds_read_b64_tr_b16 v[212:213], v233 offset:18432
    ds_read_b64_tr_b16 v[214:215], v233 offset:19456
    buffer_load_dwordx4 v[140:143], v244, s[72:75], s16 offen offset:3072 sc1
    s_waitcnt vmcnt(15) lgkmcnt(4)
    v_mfma_f32_32x32x16_bf16 v[32:47], v[228:231], v[80:83], v[32:47]
    ds_read_b64_tr_b16 v[216:217], v232 offset:20480
    ds_read_b64_tr_b16 v[218:219], v232 offset:21504
    v_mfma_f32_32x32x16_bf16 v[16:31], v[224:227], v[80:83], v[16:31]
    ds_read_b64_tr_b16 v[220:221], v233 offset:20480
    ds_read_b64_tr_b16 v[222:223], v233 offset:21504
    s_add_u32 s16, s16, 4096
    buffer_load_dwordx4 v[144:147], v244, s[72:75], s16 offen offset:0 sc1
    s_waitcnt vmcnt(15) lgkmcnt(4)
    v_mfma_f32_32x32x16_bf16 v[32:47], v[212:215], v[84:87], v[32:47]
    ds_read_b64_tr_b16 v[224:225], v232 offset:22528
    ds_read_b64_tr_b16 v[226:227], v232 offset:23552
    v_mfma_f32_32x32x16_bf16 v[16:31], v[208:211], v[84:87], v[16:31]
    ds_read_b64_tr_b16 v[228:229], v233 offset:22528
    ds_read_b64_tr_b16 v[230:231], v233 offset:23552
    buffer_load_dwordx4 v[148:151], v244, s[72:75], s16 offen offset:1024 sc1
    s_waitcnt vmcnt(15) lgkmcnt(4)
    v_mfma_f32_32x32x16_bf16 v[32:47], v[220:223], v[88:91], v[32:47]
    ds_read_b64_tr_b16 v[208:209], v232 offset:24576
    ds_read_b64_tr_b16 v[210:211], v232 offset:25600
    v_mfma_f32_32x32x16_bf16 v[16:31], v[216:219], v[88:91], v[16:31]
    ds_read_b64_tr_b16 v[212:213], v233 offset:24576
    ds_read_b64_tr_b16 v[214:215], v233 offset:25600
    buffer_load_dwordx4 v[152:155], v244, s[72:75], s16 offen offset:2048 sc1
    s_waitcnt vmcnt(15) lgkmcnt(4)
    v_mfma_f32_32x32x16_bf16 v[32:47], v[228:231], v[92:95], v[32:47]
    ds_read_b64_tr_b16 v[216:217], v232 offset:26624
    ds_read_b64_tr_b16 v[218:219], v232 offset:27648
    v_mfma_f32_32x32x16_bf16 v[16:31], v[224:227], v[92:95], v[16:31]
    ds_read_b64_tr_b16 v[220:221], v233 offset:26624
    ds_read_b64_tr_b16 v[222:223], v233 offset:27648
    buffer_load_dwordx4 v[156:159], v244, s[72:75], s16 offen offset:3072 sc1
    s_waitcnt vmcnt(15) lgkmcnt(4)
    v_mfma_f32_32x32x16_bf16 v[32:47], v[212:215], v[96:99], v[32:47]
    ds_read_b64_tr_b16 v[224:225], v232 offset:28672
    ds_read_b64_tr_b16 v[226:227], v232 offset:29696
    v_mfma_f32_32x32x16_bf16 v[16:31], v[208:211], v[96:99], v[16:31]
    ds_read_b64_tr_b16 v[228:229], v233 offset:28672
    ds_read_b64_tr_b16 v[230:231], v233 offset:29696
    s_add_u32 s16, s16, 4096
    buffer_load_dwordx4 v[160:163], v244, s[72:75], s16 offen offset:0 sc1
    s_waitcnt vmcnt(15) lgkmcnt(4)
    v_mfma_f32_32x32x16_bf16 v[32:47], v[220:223], v[100:103], v[32:47]
    ds_read_b64_tr_b16 v[208:209], v234 offset:0
    ds_read_b64_tr_b16 v[210:211], v234 offset:1024
    v_mfma_f32_32x32x16_bf16 v[16:31], v[216:219], v[100:103], v[16:31]
    ds_read_b64_tr_b16 v[212:213], v235 offset:0
    ds_read_b64_tr_b16 v[214:215], v235 offset:1024
    buffer_load_dwordx4 v[164:167], v244, s[72:75], s16 offen offset:1024 sc1
    s_waitcnt vmcnt(15) lgkmcnt(4)
    v_mfma_f32_32x32x16_bf16 v[32:47], v[228:231], v[104:107], v[32:47]
    ds_read_b64_tr_b16 v[216:217], v234 offset:2048
    ds_read_b64_tr_b16 v[218:219], v234 offset:3072
    v_mfma_f32_32x32x16_bf16 v[16:31], v[224:227], v[104:107], v[16:31]
    ds_read_b64_tr_b16 v[220:221], v235 offset:2048
    ds_read_b64_tr_b16 v[222:223], v235 offset:3072
    buffer_load_dwordx4 v[168:171], v244, s[72:75], s16 offen offset:2048 sc1
    s_waitcnt vmcnt(15) lgkmcnt(4)
    v_mfma_f32_32x32x16_bf16 v[32:47], v[212:215], v[108:111], v[32:47]
    ds_read_b64_tr_b16 v[224:225], v234 offset:4096
    ds_read_b64_tr_b16 v[226:227], v234 offset:5120
    v_mfma_f32_32x32x16_bf16 v[16:31], v[208:211], v[108:111], v[16:31]
    ds_read_b64_tr_b16 v[228:229], v235 offset:4096
    ds_read_b64_tr_b16 v[230:231], v235 offset:5120
    buffer_load_dwordx4 v[172:175], v244, s[72:75], s16 offen offset:3072 sc1
    s_waitcnt vmcnt(15) lgkmcnt(4)
    v_mfma_f32_32x32x16_bf16 v[32:47], v[220:223], v[112:115], v[32:47]
    ds_read_b64_tr_b16 v[208:209], v234 offset:6144
    ds_read_b64_tr_b16 v[210:211], v234 offset:7168
    v_mfma_f32_32x32x16_bf16 v[16:31], v[216:219], v[112:115], v[16:31]
    ds_read_b64_tr_b16 v[212:213], v235 offset:6144
    ds_read_b64_tr_b16 v[214:215], v235 offset:7168
    s_add_u32 s16, s16, 4096
    buffer_load_dwordx4 v[176:179], v244, s[72:75], s16 offen offset:0 sc1
    s_waitcnt vmcnt(15) lgkmcnt(4)
    v_mfma_f32_32x32x16_bf16 v[32:47], v[228:231], v[116:119], v[32:47]
    ds_read_b64_tr_b16 v[216:217], v234 offset:8192
    ds_read_b64_tr_b16 v[218:219], v234 offset:9216
    v_mfma_f32_32x32x16_bf16 v[16:31], v[224:227], v[116:119], v[16:31]
    ds_read_b64_tr_b16 v[220:221], v235 offset:8192
    ds_read_b64_tr_b16 v[222:223], v235 offset:9216
    buffer_load_dwordx4 v[180:183], v244, s[72:75], s16 offen offset:1024 sc1
    s_waitcnt vmcnt(15) lgkmcnt(4)
    v_mfma_f32_32x32x16_bf16 v[32:47], v[212:215], v[120:123], v[32:47]
    ds_read_b64_tr_b16 v[224:225], v234 offset:10240
    ds_read_b64_tr_b16 v[226:227], v234 offset:11264
    v_mfma_f32_32x32x16_bf16 v[16:31], v[208:211], v[120:123], v[16:31]
    ds_read_b64_tr_b16 v[228:229], v235 offset:10240
    ds_read_b64_tr_b16 v[230:231], v235 offset:11264
    buffer_load_dwordx4 v[184:187], v244, s[72:75], s16 offen offset:2048 sc1
    s_waitcnt vmcnt(15) lgkmcnt(4)
    v_mfma_f32_32x32x16_bf16 v[32:47], v[220:223], v[124:127], v[32:47]
    ds_read_b64_tr_b16 v[208:209], v234 offset:12288
    ds_read_b64_tr_b16 v[210:211], v234 offset:13312
    v_mfma_f32_32x32x16_bf16 v[16:31], v[216:219], v[124:127], v[16:31]
    ds_read_b64_tr_b16 v[212:213], v235 offset:12288
    ds_read_b64_tr_b16 v[214:215], v235 offset:13312
    buffer_load_dwordx4 v[188:191], v244, s[72:75], s16 offen offset:3072 sc1
    s_waitcnt vmcnt(15) lgkmcnt(4)
    v_mfma_f32_32x32x16_bf16 v[32:47], v[228:231], v[128:131], v[32:47]
    ds_read_b64_tr_b16 v[216:217], v234 offset:14336
    ds_read_b64_tr_b16 v[218:219], v234 offset:15360
    v_mfma_f32_32x32x16_bf16 v[16:31], v[224:227], v[128:131], v[16:31]
    ds_read_b64_tr_b16 v[220:221], v235 offset:14336
    ds_read_b64_tr_b16 v[222:223], v235 offset:15360
    s_add_u32 s16, s16, 4096
    buffer_load_dwordx4 v[192:195], v244, s[72:75], s16 offen offset:0 sc1
    s_waitcnt vmcnt(15) lgkmcnt(4)
    v_mfma_f32_32x32x16_bf16 v[32:47], v[212:215], v[132:135], v[32:47]
    ds_read_b64_tr_b16 v[224:225], v234 offset:16384
    ds_read_b64_tr_b16 v[226:227], v234 offset:17408
    v_mfma_f32_32x32x16_bf16 v[16:31], v[208:211], v[132:135], v[16:31]
    ds_read_b64_tr_b16 v[228:229], v235 offset:16384
    ds_read_b64_tr_b16 v[230:231], v235 offset:17408
    buffer_load_dwordx4 v[196:199], v244, s[72:75], s16 offen offset:1024 sc1
    s_waitcnt vmcnt(15) lgkmcnt(4)
    v_mfma_f32_32x32x16_bf16 v[32:47], v[220:223], v[136:139], v[32:47]
    ds_read_b64_tr_b16 v[208:209], v234 offset:18432
    ds_read_b64_tr_b16 v[210:211], v234 offset:19456
    v_mfma_f32_32x32x16_bf16 v[16:31], v[216:219], v[136:139], v[16:31]
    ds_read_b64_tr_b16 v[212:213], v235 offset:18432
    ds_read_b64_tr_b16 v[214:215], v235 offset:19456
    buffer_load_dwordx4 v[200:203], v244, s[72:75], s16 offen offset:2048 sc1
    s_waitcnt vmcnt(15) lgkmcnt(4)
    v_mfma_f32_32x32x16_bf16 v[32:47], v[228:231], v[140:143], v[32:47]
    ds_read_b64_tr_b16 v[216:217], v234 offset:20480
    ds_read_b64_tr_b16 v[218:219], v234 offset:21504
    v_mfma_f32_32x32x16_bf16 v[16:31], v[224:227], v[140:143], v[16:31]
    ds_read_b64_tr_b16 v[220:221], v235 offset:20480
    ds_read_b64_tr_b16 v[222:223], v235 offset:21504
    buffer_load_dwordx4 v[204:207], v244, s[72:75], s16 offen offset:3072 sc1
    s_waitcnt vmcnt(15) lgkmcnt(4)
    v_mfma_f32_32x32x16_bf16 v[32:47], v[212:215], v[144:147], v[32:47]
    ds_read_b64_tr_b16 v[224:225], v234 offset:22528
    ds_read_b64_tr_b16 v[226:227], v234 offset:23552
    v_mfma_f32_32x32x16_bf16 v[16:31], v[208:211], v[144:147], v[16:31]
    ds_read_b64_tr_b16 v[228:229], v235 offset:22528
    ds_read_b64_tr_b16 v[230:231], v235 offset:23552
    s_add_u32 s16, s16, 4096
    buffer_load_dwordx4 v[48:51], v244, s[72:75], s16 offen offset:0 sc1
    s_waitcnt vmcnt(15) lgkmcnt(4)
    v_mfma_f32_32x32x16_bf16 v[32:47], v[220:223], v[148:151], v[32:47]
    ds_read_b64_tr_b16 v[208:209], v234 offset:24576
    ds_read_b64_tr_b16 v[210:211], v234 offset:25600
    v_mfma_f32_32x32x16_bf16 v[16:31], v[216:219], v[148:151], v[16:31]
    ds_read_b64_tr_b16 v[212:213], v235 offset:24576
    ds_read_b64_tr_b16 v[214:215], v235 offset:25600
    buffer_load_dwordx4 v[52:55], v244, s[72:75], s16 offen offset:1024 sc1
    s_waitcnt vmcnt(15) lgkmcnt(4)
    v_mfma_f32_32x32x16_bf16 v[32:47], v[228:231], v[152:155], v[32:47]
    ds_read_b64_tr_b16 v[216:217], v234 offset:26624
    ds_read_b64_tr_b16 v[218:219], v234 offset:27648
    v_mfma_f32_32x32x16_bf16 v[16:31], v[224:227], v[152:155], v[16:31]
    ds_read_b64_tr_b16 v[220:221], v235 offset:26624
    ds_read_b64_tr_b16 v[222:223], v235 offset:27648
    buffer_load_dwordx4 v[56:59], v244, s[72:75], s16 offen offset:2048 sc1
    s_waitcnt vmcnt(15) lgkmcnt(4)
    v_mfma_f32_32x32x16_bf16 v[32:47], v[212:215], v[156:159], v[32:47]
    ds_read_b64_tr_b16 v[224:225], v234 offset:28672
    ds_read_b64_tr_b16 v[226:227], v234 offset:29696
    v_mfma_f32_32x32x16_bf16 v[16:31], v[208:211], v[156:159], v[16:31]
    ds_read_b64_tr_b16 v[228:229], v235 offset:28672
    ds_read_b64_tr_b16 v[230:231], v235 offset:29696
    s_waitcnt vmcnt(14) lgkmcnt(4)
    v_mfma_f32_32x32x16_bf16 v[32:47], v[220:223], v[160:163], v[32:47]
    ds_read_b64_tr_b16 v[208:209], v234 offset:30720
    ds_read_b64_tr_b16 v[210:211], v234 offset:31744
    v_mfma_f32_32x32x16_bf16 v[16:31], v[216:219], v[160:163], v[16:31]
    ds_read_b64_tr_b16 v[212:213], v235 offset:30720
    ds_read_b64_tr_b16 v[214:215], v235 offset:31744
    s_waitcnt vmcnt(13) lgkmcnt(4)
    v_mfma_f32_32x32x16_bf16 v[32:47], v[228:231], v[164:167], v[32:47]
    ds_read_b64_tr_b16 v[216:217], v234 offset:32768
    ds_read_b64_tr_b16 v[218:219], v234 offset:33792
    v_mfma_f32_32x32x16_bf16 v[16:31], v[224:227], v[164:167], v[16:31]
    ds_read_b64_tr_b16 v[220:221], v235 offset:32768
    ds_read_b64_tr_b16 v[222:223], v235 offset:33792
    s_waitcnt vmcnt(12) lgkmcnt(4)
    v_mfma_f32_32x32x16_bf16 v[32:47], v[212:215], v[168:171], v[32:47]
    ds_read_b64_tr_b16 v[224:225], v234 offset:34816
    ds_read_b64_tr_b16 v[226:227], v234 offset:35840
    v_mfma_f32_32x32x16_bf16 v[16:31], v[208:211], v[168:171], v[16:31]
    ds_read_b64_tr_b16 v[228:229], v235 offset:34816
    ds_read_b64_tr_b16 v[230:231], v235 offset:35840
    s_waitcnt vmcnt(11) lgkmcnt(4)
    v_mfma_f32_32x32x16_bf16 v[32:47], v[220:223], v[172:175], v[32:47]
    ds_read_b64_tr_b16 v[208:209], v234 offset:36864
    ds_read_b64_tr_b16 v[210:211], v234 offset:37888
    v_mfma_f32_32x32x16_bf16 v[16:31], v[216:219], v[172:175], v[16:31]
    ds_read_b64_tr_b16 v[212:213], v235 offset:36864
    ds_read_b64_tr_b16 v[214:215], v235 offset:37888
    s_waitcnt vmcnt(10) lgkmcnt(4)
    v_mfma_f32_32x32x16_bf16 v[32:47], v[228:231], v[176:179], v[32:47]
    ds_read_b64_tr_b16 v[216:217], v234 offset:38912
    ds_read_b64_tr_b16 v[218:219], v234 offset:39936
    v_mfma_f32_32x32x16_bf16 v[16:31], v[224:227], v[176:179], v[16:31]
    ds_read_b64_tr_b16 v[220:221], v235 offset:38912
    ds_read_b64_tr_b16 v[222:223], v235 offset:39936
    s_waitcnt vmcnt(9) lgkmcnt(4)
    v_mfma_f32_32x32x16_bf16 v[32:47], v[212:215], v[180:183], v[32:47]
    ds_read_b64_tr_b16 v[224:225], v234 offset:40960
    ds_read_b64_tr_b16 v[226:227], v234 offset:41984
    v_mfma_f32_32x32x16_bf16 v[16:31], v[208:211], v[180:183], v[16:31]
    ds_read_b64_tr_b16 v[228:229], v235 offset:40960
    ds_read_b64_tr_b16 v[230:231], v235 offset:41984
    s_waitcnt vmcnt(8) lgkmcnt(4)
    v_mfma_f32_32x32x16_bf16 v[32:47], v[220:223], v[184:187], v[32:47]
    ds_read_b64_tr_b16 v[208:209], v234 offset:43008
    ds_read_b64_tr_b16 v[210:211], v234 offset:44032
    v_mfma_f32_32x32x16_bf16 v[16:31], v[216:219], v[184:187], v[16:31]
    ds_read_b64_tr_b16 v[212:213], v235 offset:43008
    ds_read_b64_tr_b16 v[214:215], v235 offset:44032
    s_waitcnt vmcnt(7) lgkmcnt(4)
    v_mfma_f32_32x32x16_bf16 v[32:47], v[228:231], v[188:191], v[32:47]
    ds_read_b64_tr_b16 v[216:217], v234 offset:45056
    ds_read_b64_tr_b16 v[218:219], v234 offset:46080
    v_mfma_f32_32x32x16_bf16 v[16:31], v[224:227], v[188:191], v[16:31]
    ds_read_b64_tr_b16 v[220:221], v235 offset:45056
    ds_read_b64_tr_b16 v[222:223], v235 offset:46080
    s_waitcnt vmcnt(6) lgkmcnt(4)
    s_barrier
    v_mfma_f32_32x32x16_bf16 v[32:47], v[212:215], v[192:195], v[32:47]
    ds_read_b64_tr_b16 v[224:225], v234 offset:47104
    ds_read_b64_tr_b16 v[226:227], v234 offset:48128
    v_mfma_f32_32x32x16_bf16 v[16:31], v[208:211], v[192:195], v[16:31]
    ds_read_b64_tr_b16 v[228:229], v235 offset:47104
    ds_read_b64_tr_b16 v[230:231], v235 offset:48128
    s_waitcnt vmcnt(5) lgkmcnt(4)
    v_mfma_f32_32x32x16_bf16 v[32:47], v[220:223], v[196:199], v[32:47]
    ds_read_b64_tr_b16 v[208:209], v232 offset:0
    ds_read_b64_tr_b16 v[210:211], v232 offset:1024
    v_mfma_f32_32x32x16_bf16 v[16:31], v[216:219], v[196:199], v[16:31]
    ds_read_b64_tr_b16 v[212:213], v233 offset:0
    ds_read_b64_tr_b16 v[214:215], v233 offset:1024
    s_waitcnt vmcnt(4) lgkmcnt(4)
    v_mfma_f32_32x32x16_bf16 v[32:47], v[228:231], v[200:203], v[32:47]
    ds_read_b64_tr_b16 v[216:217], v232 offset:2048
    ds_read_b64_tr_b16 v[218:219], v232 offset:3072
    v_mfma_f32_32x32x16_bf16 v[16:31], v[224:227], v[200:203], v[16:31]
    ds_read_b64_tr_b16 v[220:221], v233 offset:2048
    ds_read_b64_tr_b16 v[222:223], v233 offset:3072
    s_waitcnt vmcnt(3) lgkmcnt(4)
    v_mfma_f32_32x32x16_bf16 v[32:47], v[212:215], v[204:207], v[32:47]
    ds_read_b64_tr_b16 v[224:225], v232 offset:4096
    ds_read_b64_tr_b16 v[226:227], v232 offset:5120
    v_mfma_f32_32x32x16_bf16 v[16:31], v[208:211], v[204:207], v[16:31]
    ds_read_b64_tr_b16 v[228:229], v233 offset:4096
    ds_read_b64_tr_b16 v[230:231], v233 offset:5120
    s_waitcnt vmcnt(2) lgkmcnt(4)
    v_mfma_f32_32x32x16_bf16 v[32:47], v[220:223], v[48:51], v[32:47]
    ds_read_b64_tr_b16 v[208:209], v232 offset:6144
    ds_read_b64_tr_b16 v[210:211], v232 offset:7168
    v_mfma_f32_32x32x16_bf16 v[16:31], v[216:219], v[48:51], v[16:31]
    ds_read_b64_tr_b16 v[212:213], v233 offset:6144
    ds_read_b64_tr_b16 v[214:215], v233 offset:7168
    s_waitcnt vmcnt(1) lgkmcnt(4)
    v_mfma_f32_32x32x16_bf16 v[32:47], v[228:231], v[52:55], v[32:47]
    v_mfma_f32_32x32x16_bf16 v[16:31], v[224:227], v[52:55], v[16:31]
    s_waitcnt vmcnt(0) lgkmcnt(0)
    v_mfma_f32_32x32x16_bf16 v[32:47], v[212:215], v[56:59], v[32:47]
    v_mfma_f32_32x32x16_bf16 v[16:31], v[208:211], v[56:59], v[16:31]
    s_nop 10
    ds_write_b128 v236, v[32:35] offset:0
    ds_write_b128 v236, v[36:39] offset:1024
    ds_write_b128 v236, v[40:43] offset:2048
    ds_write_b128 v236, v[44:47] offset:3072
    s_waitcnt lgkmcnt(0)
    s_barrier
    ds_read_b128 v[32:35], v237 offset:0
    ds_read_b128 v[36:39], v237 offset:1024
    ds_read_b128 v[40:43], v237 offset:2048
    ds_read_b128 v[44:47], v237 offset:3072
    s_waitcnt lgkmcnt(3)
    v_pk_add_f32 v[16:17], v[16:17], v[32:33]
    v_pk_add_f32 v[18:19], v[18:19], v[34:35]
    v_cvt_pk_bf16_f32 v8, v16, v17
    v_cvt_pk_bf16_f32 v9, v18, v19
    s_waitcnt lgkmcnt(2)
    v_pk_add_f32 v[20:21], v[20:21], v[36:37]
    v_pk_add_f32 v[22:23], v[22:23], v[38:39]
    v_cvt_pk_bf16_f32 v10, v20, v21
    v_cvt_pk_bf16_f32 v11, v22, v23
    s_nop 0
    v_permlane32_swap_b32 v8, v10
    v_permlane32_swap_b32 v9, v11
    buffer_store_dwordx4 v[8:11], v4, s[68:71], s24 offen offset:0
    s_waitcnt lgkmcnt(1)
    v_pk_add_f32 v[24:25], v[24:25], v[40:41]
    v_pk_add_f32 v[26:27], v[26:27], v[42:43]
    v_cvt_pk_bf16_f32 v12, v24, v25
    v_cvt_pk_bf16_f32 v13, v26, v27
    s_waitcnt lgkmcnt(0)
    v_pk_add_f32 v[28:29], v[28:29], v[44:45]
    v_pk_add_f32 v[30:31], v[30:31], v[46:47]
    v_cvt_pk_bf16_f32 v14, v28, v29
    v_cvt_pk_bf16_f32 v15, v30, v31
    s_nop 0
    v_permlane32_swap_b32 v12, v14
    v_permlane32_swap_b32 v13, v15
    buffer_store_dwordx4 v[12:15], v4, s[68:71], s24 offen offset:32
    s_endpgm
Lloader2:
    s_cmp_ge_u32 s82, 2
    s_cbranch_scc1 L72
    s_getpc_b64 s[10:11]
Lct1:
    s_mov_b32 s13, Lct1-Ls3
    s_cmp_eq_u32 s82, 1
    s_cselect_b32 s13, Lct1-Lcodeend+8192, s13
    s_sub_u32 s10, s10, s13
    s_subb_u32 s11, s11, 0
    global_load_dword v239, v245, s[10:11]
L72:
    s_barrier
    s_cmp_eq_u32 s7, 15
    s_cbranch_scc1 L73
    s_mul_i32 s16, s82, 44032
    s_mul_i32 s13, s7, 192
    s_add_u32 s16, s16, s13
    s_mul_i32 s18, s82, 3072
    s_add_u32 s13, s16, 660480
    s_add_u32 m0, s18, 52224
    s_nop 0
    buffer_load_dwordx4 v8, s[52:55], s13 offen lds
    s_add_u32 s13, s16, 660480
    s_add_u32 m0, s18, 53248
    s_nop 0
    buffer_load_dwordx4 v9, s[52:55], s13 offen lds
    s_add_u32 s13, s16, 660480
    s_add_u32 m0, s18, 54272
    s_nop 0
    buffer_load_dwordx4 v10, s[52:55], s13 offen lds
    s_add_u32 s13, s16, 836608
    s_add_u32 m0, s18, 64512
    s_nop 0
    buffer_load_dwordx4 v8, s[52:55], s13 offen lds
    s_add_u32 s13, s16, 836608
    s_add_u32 m0, s18, 65536
    s_nop 0
    buffer_load_dwordx4 v9, s[52:55], s13 offen lds
    s_add_u32 s13, s16, 836608
    s_add_u32 m0, s18, 66560
    s_nop 0
    buffer_load_dwordx4 v10, s[52:55], s13 offen lds
    s_add_u32 s13, s16, 1012736
    s_add_u32 m0, s18, 76800
    s_nop 0
    buffer_load_dwordx4 v8, s[52:55], s13 offen lds
    s_add_u32 s13, s16, 1012736
    s_add_u32 m0, s18, 77824
    s_nop 0
    buffer_load_dwordx4 v9, s[52:55], s13 offen lds
    s_add_u32 s13, s16, 1012736
    s_add_u32 m0, s18, 78848
    s_nop 0
    buffer_load_dwordx4 v10, s[52:55], s13 offen lds
    s_add_u32 s14, s82, 29
    s_and_b32 s14, s14, 31
    s_mul_i32 s14, s14, 3072
    s_add_u32 s13, s16, 1188864
    s_add_u32 m0, s14, 0
    s_nop 0
    buffer_load_dwordx4 v8, s[52:55], s13 offen lds
    s_add_u32 s13, s16, 1188864
    s_add_u32 m0, s14, 1024
    s_nop 0
    buffer_load_dwordx4 v9, s[52:55], s13 offen lds
    s_add_u32 s13, s16, 1188864
    s_add_u32 m0, s14, 2048
    s_nop 0
    buffer_load_dwordx4 v10, s[52:55], s13 offen lds
    s_cmp_lg_u32 s82, 0
    s_cbranch_scc1 L73
    s_add_u32 s13, s16, 1364992
    s_mov_b32 m0, 3072
    s_nop 0
    buffer_load_dwordx4 v8, s[52:55], s13 offen lds
    s_add_u32 s13, s16, 1364992
    s_mov_b32 m0, 4096
    s_nop 0
    buffer_load_dwordx4 v9, s[52:55], s13 offen lds
    s_add_u32 s13, s16, 1364992
    s_mov_b32 m0, 5120
    s_nop 0
    buffer_load_dwordx4 v10, s[52:55], s13 offen lds
L73:
    s_mul_i32 s13, s7, 192
    v_lshlrev_b32 v2, 1, v0
    buffer_load_ushort v12, v2, s[56:59], s13 offen
    buffer_load_ushort v13, v2, s[56:59], s13 offen offset:128
    s_lshl_b32 s13, s5, 7
    buffer_load_ushort v14, v2, s[64:67], s13 offen
    v_mov_b32 v2, 0
    v_mov_b32 v3, 101376
    ds_write_b32 v3, v2
    s_mul_i32 s16, s81, 704512
    s_lshl_b32 s13, s80, 13
    s_add_u32 s16, s16, s13
    s_lshl_b32 s13, s5, 7
    s_add_u32 s16, s16, s13
    s_add_u32 s16, s16, 131072
    s_mul_i32 s18, s81, 30720
    s_lshl_b32 s13, s80, 10
    s_add_u32 s18, s18, s13
    s_add_u32 s18, s18, 118784
    s_mov_b32 s19, 7
L74:
    s_mov_b32 m0, s18
    s_nop 0
    buffer_load_dwordx4 v243, s[60:63], s16 offen lds
    s_add_u32 s16, s16, 16384
    s_add_u32 s18, s18, 2048
    s_sub_u32 s19, s19, 1
    s_cmp_lg_u32 s19, 0
    s_cbranch_scc1 L74
    s_cmp_eq_u32 s81, 0
    s_cbranch_scc1 L75
    s_mul_i32 s16, s81, 704512
    s_lshl_b32 s13, s80, 13
    s_add_u32 s16, s16, s13
    s_lshl_b32 s13, s5, 7
    s_add_u32 s16, s16, s13
    s_add_u32 s16, s16, 0
    s_mul_i32 s18, s81, 30720
    s_lshl_b32 s13, s80, 10
    s_add_u32 s18, s18, s13
    s_add_u32 s18, s18, 102400
    s_mov_b32 s19, 8
L76:
    s_mov_b32 m0, s18
    s_nop 0
    buffer_load_dwordx4 v243, s[60:63], s16 offen lds
    s_add_u32 s16, s16, 16384
    s_add_u32 s18, s18, 2048
    s_sub_u32 s19, s19, 1
    s_cmp_lg_u32 s19, 0
    s_cbranch_scc1 L76
L75:
    v_lshrrev_b32 v2, 5, v0
    v_mul_u32_u24 v2, 4, v2
    v_bfe_u32 v4, v0, 2, 2
    v_add_u32 v2, v2, v4
    v_mul_u32_u24 v2, 192, v2
    v_bfe_u32 v4, v0, 4, 1
    v_lshl_add_u32 v2, v4, 5, v2
    v_and_b32 v4, 3, v0
    v_lshl_add_u32 v2, v4, 3, v2
    s_mul_i32 s13, s82, 24576
    v_add_u32 v2, s13, v2
    v_mov_b32 v3, 0x3f803f80
    v_mov_b32 v16, 0
    v_mov_b32 v17, 0
    v_mov_b32 v18, 0
    v_mov_b32 v19, 0
    v_mov_b32 v20, 0
    v_mov_b32 v21, 0
    s_waitcnt lgkmcnt(0)
    s_barrier
    s_waitcnt vmcnt(0)
    v_lshlrev_b32 v4, 2, v0
    v_add_u32 v4, 98304, v4
    v_lshlrev_b32 v14, 16, v14
    ds_write_b32 v4, v14 offset:3328
    s_cmp_eq_u32 s7, 15
    s_cbranch_scc1 Lnocs
    v_mov_b32 v6, 101376
    v_mov_b32 v7, 1
    s_mov_b64 exec, 1
    ds_add_u32 v6, v7
    s_mov_b64 exec, -1
    v_mov_b32 v6, 101376
    s_mov_b32 s8, 0
Llw77:
    ds_read_b32 v7, v6
    s_add_u32 s8, s8, 1
    s_waitcnt lgkmcnt(0)
    v_readfirstlane_b32 s9, v7
    s_cmp_gt_u32 s8, 1600000
    s_cbranch_scc1 Llwd78
    s_cmp_lt_u32 s9, 4
    s_cbranch_scc1 Llw77
Llwd78:
    ds_read_b64_tr_b16 v[32:33], v2 offset:0
    ds_read_b64_tr_b16 v[34:35], v2 offset:1536
    ds_read_b64_tr_b16 v[36:37], v2 offset:64
    ds_read_b64_tr_b16 v[38:39], v2 offset:1600
    ds_read_b64_tr_b16 v[40:41], v2 offset:128
    ds_read_b64_tr_b16 v[42:43], v2 offset:1664
    ds_read_b64_tr_b16 v[44:45], v2 offset:3072
    ds_read_b64_tr_b16 v[46:47], v2 offset:4608
    ds_read_b64_tr_b16 v[48:49], v2 offset:3136
    ds_read_b64_tr_b16 v[50:51], v2 offset:4672
    ds_read_b64_tr_b16 v[52:53], v2 offset:3200
    ds_read_b64_tr_b16 v[54:55], v2 offset:4736
    ds_read_b64_tr_b16 v[56:57], v2 offset:6144
    ds_read_b64_tr_b16 v[58:59], v2 offset:7680
    ds_read_b64_tr_b16 v[60:61], v2 offset:6208
    ds_read_b64_tr_b16 v[62:63], v2 offset:7744
    ds_read_b64_tr_b16 v[64:65], v2 offset:6272
    ds_read_b64_tr_b16 v[66:67], v2 offset:7808
    ds_read_b64_tr_b16 v[68:69], v2 offset:9216
    ds_read_b64_tr_b16 v[70:71], v2 offset:10752
    ds_read_b64_tr_b16 v[72:73], v2 offset:9280
    ds_read_b64_tr_b16 v[74:75], v2 offset:10816
    ds_read_b64_tr_b16 v[76:77], v2 offset:9344
    ds_read_b64_tr_b16 v[78:79], v2 offset:10880
    s_waitcnt lgkmcnt(0)
    v_dot2c_f32_bf16 v16, v32, v3
    v_dot2c_f32_bf16 v18, v36, v3
    v_dot2c_f32_bf16 v20, v40, v3
    v_dot2c_f32_bf16 v17, v33, v3
    v_dot2c_f32_bf16 v19, v37, v3
    v_dot2c_f32_bf16 v21, v41, v3
    v_dot2c_f32_bf16 v16, v34, v3
    v_dot2c_f32_bf16 v18, v38, v3
    v_dot2c_f32_bf16 v20, v42, v3
    v_dot2c_f32_bf16 v17, v35, v3
    v_dot2c_f32_bf16 v19, v39, v3
    v_dot2c_f32_bf16 v21, v43, v3
    v_dot2c_f32_bf16 v16, v44, v3
    v_dot2c_f32_bf16 v18, v48, v3
    v_dot2c_f32_bf16 v20, v52, v3
    v_dot2c_f32_bf16 v17, v45, v3
    v_dot2c_f32_bf16 v19, v49, v3
    v_dot2c_f32_bf16 v21, v53, v3
    v_dot2c_f32_bf16 v16, v46, v3
    v_dot2c_f32_bf16 v18, v50, v3
    v_dot2c_f32_bf16 v20, v54, v3
    v_dot2c_f32_bf16 v17, v47, v3
    v_dot2c_f32_bf16 v19, v51, v3
    v_dot2c_f32_bf16 v21, v55, v3
    v_dot2c_f32_bf16 v16, v56, v3
    v_dot2c_f32_bf16 v18, v60, v3
    v_dot2c_f32_bf16 v20, v64, v3
    v_dot2c_f32_bf16 v17, v57, v3
    v_dot2c_f32_bf16 v19, v61, v3
    v_dot2c_f32_bf16 v21, v65, v3
    v_dot2c_f32_bf16 v16, v58, v3
    v_dot2c_f32_bf16 v18, v62, v3
    v_dot2c_f32_bf16 v20, v66, v3
    v_dot2c_f32_bf16 v17, v59, v3
    v_dot2c_f32_bf16 v19, v63, v3
    v_dot2c_f32_bf16 v21, v67, v3
    v_dot2c_f32_bf16 v16, v68, v3
    v_dot2c_f32_bf16 v18, v72, v3
    v_dot2c_f32_bf16 v20, v76, v3
    v_dot2c_f32_bf16 v17, v69, v3
    v_dot2c_f32_bf16 v19, v73, v3
    v_dot2c_f32_bf16 v21, v77, v3
    v_dot2c_f32_bf16 v16, v70, v3
    v_dot2c_f32_bf16 v18, v74, v3
    v_dot2c_f32_bf16 v20, v78, v3
    v_dot2c_f32_bf16 v17, v71, v3
    v_dot2c_f32_bf16 v19, v75, v3
    v_dot2c_f32_bf16 v21, v79, v3
    ds_read_b64_tr_b16 v[32:33], v2 offset:12288
    ds_read_b64_tr_b16 v[34:35], v2 offset:13824
    ds_read_b64_tr_b16 v[36:37], v2 offset:12352
    ds_read_b64_tr_b16 v[38:39], v2 offset:13888
    ds_read_b64_tr_b16 v[40:41], v2 offset:12416
    ds_read_b64_tr_b16 v[42:43], v2 offset:13952
    ds_read_b64_tr_b16 v[44:45], v2 offset:15360
    ds_read_b64_tr_b16 v[46:47], v2 offset:16896
    ds_read_b64_tr_b16 v[48:49], v2 offset:15424
    ds_read_b64_tr_b16 v[50:51], v2 offset:16960
    ds_read_b64_tr_b16 v[52:53], v2 offset:15488
    ds_read_b64_tr_b16 v[54:55], v2 offset:17024
    ds_read_b64_tr_b16 v[56:57], v2 offset:18432
    ds_read_b64_tr_b16 v[58:59], v2 offset:19968
    ds_read_b64_tr_b16 v[60:61], v2 offset:18496
    ds_read_b64_tr_b16 v[62:63], v2 offset:20032
    ds_read_b64_tr_b16 v[64:65], v2 offset:18560
    ds_read_b64_tr_b16 v[66:67], v2 offset:20096
    ds_read_b64_tr_b16 v[68:69], v2 offset:21504
    ds_read_b64_tr_b16 v[70:71], v2 offset:23040
    ds_read_b64_tr_b16 v[72:73], v2 offset:21568
    ds_read_b64_tr_b16 v[74:75], v2 offset:23104
    ds_read_b64_tr_b16 v[76:77], v2 offset:21632
    ds_read_b64_tr_b16 v[78:79], v2 offset:23168
    s_waitcnt lgkmcnt(0)
    v_dot2c_f32_bf16 v16, v32, v3
    v_dot2c_f32_bf16 v18, v36, v3
    v_dot2c_f32_bf16 v20, v40, v3
    v_dot2c_f32_bf16 v17, v33, v3
    v_dot2c_f32_bf16 v19, v37, v3
    v_dot2c_f32_bf16 v21, v41, v3
    v_dot2c_f32_bf16 v16, v34, v3
    v_dot2c_f32_bf16 v18, v38, v3
    v_dot2c_f32_bf16 v20, v42, v3
    v_dot2c_f32_bf16 v17, v35, v3
    v_dot2c_f32_bf16 v19, v39, v3
    v_dot2c_f32_bf16 v21, v43, v3
    v_dot2c_f32_bf16 v16, v44, v3
    v_dot2c_f32_bf16 v18, v48, v3
    v_dot2c_f32_bf16 v20, v52, v3
    v_dot2c_f32_bf16 v17, v45, v3
    v_dot2c_f32_bf16 v19, v49, v3
    v_dot2c_f32_bf16 v21, v53, v3
    v_dot2c_f32_bf16 v16, v46, v3
    v_dot2c_f32_bf16 v18, v50, v3
    v_dot2c_f32_bf16 v20, v54, v3
    v_dot2c_f32_bf16 v17, v47, v3
    v_dot2c_f32_bf16 v19, v51, v3
    v_dot2c_f32_bf16 v21, v55, v3
    v_dot2c_f32_bf16 v16, v56, v3
    v_dot2c_f32_bf16 v18, v60, v3
    v_dot2c_f32_bf16 v20, v64, v3
    v_dot2c_f32_bf16 v17, v57, v3
    v_dot2c_f32_bf16 v19, v61, v3
    v_dot2c_f32_bf16 v21, v65, v3
    v_dot2c_f32_bf16 v16, v58, v3
    v_dot2c_f32_bf16 v18, v62, v3
    v_dot2c_f32_bf16 v20, v66, v3
    v_dot2c_f32_bf16 v17, v59, v3
    v_dot2c_f32_bf16 v19, v63, v3
    v_dot2c_f32_bf16 v21, v67, v3
    v_dot2c_f32_bf16 v16, v68, v3
    v_dot2c_f32_bf16 v18, v72, v3
    v_dot2c_f32_bf16 v20, v76, v3
    v_dot2c_f32_bf16 v17, v69, v3
    v_dot2c_f32_bf16 v19, v73, v3
    v_dot2c_f32_bf16 v21, v77, v3
    v_dot2c_f32_bf16 v16, v70, v3
    v_dot2c_f32_bf16 v18, v74, v3
    v_dot2c_f32_bf16 v20, v78, v3
    v_dot2c_f32_bf16 v17, v71, v3
    v_dot2c_f32_bf16 v19, v75, v3
    v_dot2c_f32_bf16 v21, v79, v3
    s_nop 0
    v_add_f32 v16, v16, v17
    v_add_f32 v18, v18, v19
    v_add_f32 v20, v20, v21
    v_mov_b32 v21, v20
    v_permlane32_swap_b32 v16, v18
    v_add_f32 v16, v16, v18
    v_permlane32_swap_b32 v20, v21
    v_add_f32 v20, v20, v21
    s_mul_i32 s13, s82, 384
    s_add_u32 s13, s13, 98304
    v_lshlrev_b32 v4, 2, v0
    v_add_u32 v5, s13, v4
    ds_write_b32 v5, v16
    s_mov_b32 exec_hi, 0
    ds_write_b32 v5, v20 offset:256
    s_mov_b32 exec_hi, -1
    s_waitcnt lgkmcnt(0)
    v_mov_b32 v6, 101376
    v_mov_b32 v7, 1
    s_mov_b64 exec, 1
    ds_add_u32 v6, v7
    s_mov_b64 exec, -1
    v_mov_b32 v6, 101376
    s_mov_b32 s8, 0
Llw79:
    ds_read_b32 v7, v6
    s_add_u32 s8, s8, 1
    s_waitcnt lgkmcnt(0)
    v_readfirstlane_b32 s9, v7
    s_cmp_gt_u32 s8, 1600000
    s_cbranch_scc1 Llwd80
    s_cmp_lt_u32 s9, 8
    s_cbranch_scc1 Llw79
Llwd80:
    v_add_u32 v4, 98304, v4
    ds_read_b32 v16, v4 offset:0
    ds_read_b32 v20, v4 offset:256
    ds_read_b32 v17, v4 offset:384
    ds_read_b32 v21, v4 offset:640
    ds_read_b32 v18, v4 offset:768
    ds_read_b32 v22, v4 offset:1024
    ds_read_b32 v19, v4 offset:1152
    ds_read_b32 v23, v4 offset:1408
    s_waitcnt lgkmcnt(0)
    v_add_f32 v16, v16, v17
    v_add_f32 v18, v18, v19
    v_add_f32 v20, v20, v21
    v_add_f32 v22, v22, v23
    v_add_f32 v16, v16, v18
    v_add_f32 v20, v20, v22
    v_lshlrev_b32 v5, 4, v0
    v_add_u32 v5, 99840, v5
    v_lshl_or_b32 v24, v12, 16, v12
    v_cvt_pk_bf16_f32 v25, -v16, -v16
    v_lshlrev_b32 v26, 16, v25
    v_mov_b32 v27, 0
    v_sub_f32 v26, -v16, v26
    v_cvt_pk_bf16_f32 v26, v26, v27
    v_lshl_or_b32 v28, v13, 16, v13
    v_cvt_pk_bf16_f32 v29, -v20, -v20
    v_lshlrev_b32 v30, 16, v29
    v_mov_b32 v31, 0
    v_sub_f32 v30, -v20, v30
    v_cvt_pk_bf16_f32 v30, v30, v31
    ds_write_b128 v5, v[24:27]
    s_mov_b32 exec_hi, 0
    ds_write_b128 v5, v[28:31] offset:1024
    s_mov_b32 exec_hi, -1
Lnocs:
    s_waitcnt lgkmcnt(0)
    s_barrier
    s_cmp_lg_u32 s81, 0
    s_cbranch_scc1 L81
    s_mul_i32 s16, s81, 704512
    s_lshl_b32 s13, s80, 13
    s_add_u32 s16, s16, s13
    s_lshl_b32 s13, s5, 7
    s_add_u32 s16, s16, s13
    s_add_u32 s16, s16, 0
    s_mul_i32 s18, s81, 30720
    s_lshl_b32 s13, s80, 10
    s_add_u32 s18, s18, s13
    s_add_u32 s18, s18, 102400
    s_mov_b32 s19, 8
L82:
    s_mov_b32 m0, s18
    s_nop 0
    buffer_load_dwordx4 v243, s[60:63], s16 offen lds
    s_add_u32 s16, s16, 16384
    s_add_u32 s18, s18, 2048
    s_sub_u32 s19, s19, 1
    s_cmp_lg_u32 s19, 0
    s_cbranch_scc1 L82
L81:
    s_cmp_lg_u32 s7, 15
    s_cbranch_scc1 L83
    s_mul_i32 s26, s80, 704512
    s_lshl_b32 s13, s81, 13
    s_add_u32 s26, s26, s13
    s_and_b32 s13, s6, 1
    s_lshl_b32 s13, s13, 14
    s_add_u32 s26, s26, s13
    s_add_u32 s26, s26, 344064
    s_mov_b32 s19, 11
    v_lshlrev_b32 v245, 7, v0
L84:
    buffer_load_dword v239, v245, s[60:63], s26 offen
    s_add_u32 s26, s26, 32768
    s_sub_u32 s19, s19, 1
    s_cmp_lg_u32 s19, 0
    s_cbranch_scc1 L84
L83:
    s_barrier
    s_waitcnt vmcnt(0)
    s_barrier
    s_mul_i32 s16, s81, 704512
    s_lshl_b32 s13, s80, 13
    s_add_u32 s16, s16, s13
    s_lshl_b32 s13, s5, 7
    s_add_u32 s16, s16, s13
    s_add_u32 s16, s16, 245760
    s_mul_i32 s18, s81, 49152
    s_lshl_b32 s13, s80, 10
    s_add_u32 s18, s18, s13
    s_add_u32 s18, s18, 0
    s_mov_b32 s19, 24
L85:
    s_mov_b32 m0, s18
    s_nop 0
    buffer_load_dwordx4 v243, s[60:63], s16 offen lds
    s_add_u32 s16, s16, 16384
    s_add_u32 s18, s18, 2048
    s_sub_u32 s19, s19, 1
    s_cmp_lg_u32 s19, 0
    s_cbranch_scc1 L85
    s_waitcnt vmcnt(0)
    s_barrier
    s_mul_i32 s18, s81, 30720
    s_lshl_b32 s13, s80, 10
    s_add_u32 s18, s18, s13
    s_add_u32 s18, s18, 102400
    s_mov_b32 s19, 4
L86:
    s_mov_b32 m0, s18
    s_nop 0
    buffer_load_dwordx4 v243, s[60:63], s16 offen lds
    s_add_u32 s16, s16, 16384
    s_add_u32 s18, s18, 2048
    s_sub_u32 s19, s19, 1
    s_cmp_lg_u32 s19, 0
    s_cbranch_scc1 L86
    s_waitcnt vmcnt(0)
    s_barrier
    s_barrier
Lexit:
    s_endpgm
Lcodeend:
.fill 64, 4, 0xbf800000
.section .rodata,"a"
.p2align 6
.amdhsa_kernel sequential_preLN__sliding_block__dense_activation_squared_relu__prompt_kernel
  .amdhsa_next_free_vgpr 256
  .amdhsa_next_free_sgpr 102
  .amdhsa_accum_offset 256
  .amdhsa_group_segment_fixed_size 0
  .amdhsa_kernarg_size 88
  .amdhsa_user_sgpr_count 2
  .amdhsa_user_sgpr_kernarg_segment_ptr 1
  .amdhsa_system_sgpr_workgroup_id_x 1
  .amdhsa_float_denorm_mode_32 3
.end_amdhsa_kernel
```
